```python
import torch

def _softmax(x, axis=-1):
    return torch.softmax(x, dim=axis)
def _gelu(x):
    return torch.nn.functional.gelu(x, approximate="tanh")
def _silu(x):
    return torch.nn.functional.silu(x)
def _sigmoid(x):
    return torch.sigmoid(x)
def _layernorm(x, axis=-1, eps=1e-5):
    m = x.mean(dim=axis, keepdim=True)
    v = x.var(dim=axis, keepdim=True, unbiased=False)
    return (x - m) / torch.sqrt(v + eps)
def _scatter_add(tgt, idx, src, axis=0):
    return tgt.clone().index_add_(axis, idx, src)
def _segment_sum(src, seg, n):
    out = torch.zeros((n,) + src.shape[1:], dtype=src.dtype)
    return out.index_add_(0, seg, src)
def _pad(x, pw):
    flat = tuple(v for pair in reversed(pw) for v in pair)
    return torch.nn.functional.pad(x, flat)

kernel_name = 'standalone__edge_featured_mpnn_egc__graph'

def setup_inputs():

    _w = (lambda a: (lambda t: t.to(torch.bfloat16) if t.is_floating_point() else t)(torch.as_tensor(a)))
    N, deg, D, De = 10000, 64, 64, max(16, 1)
    E = N * deg
    return {
        "x": _w((lambda *s: torch.randn(*s, dtype=torch.bfloat16) * 0.2)(N, D)),
        "e_attr": _w((lambda *s: torch.randn(*s, dtype=torch.bfloat16) * 0.2)(E, De)),
        "src": _w((lambda lo, hi, *s: torch.randint(lo, hi, s))(0, N, E).to(torch.int64)),
        "dst": _w((lambda lo, hi, *s: torch.randint(lo, hi, s))(0, N, E).to(torch.int64)),
        "u_w": _w((lambda *s: torch.randn(*s, dtype=torch.bfloat16) * 0.05)(D, D)),
        "v_w": _w((lambda *s: torch.randn(*s, dtype=torch.bfloat16) * 0.05)(D, D)),
        "g_w": _w((lambda *s: torch.randn(*s, dtype=torch.bfloat16) * 0.2)(2 * D + De, D)),
    }

def reference(x, e_attr, src, dst, u_w, v_w, g_w):
    N, D = x.shape
    g_in = torch.concatenate([x[dst], x[src], e_attr], axis=-1)
    eta = _sigmoid(g_in @ g_w)
    hv = x @ v_w
    msg = eta * hv[src]
    agg = _segment_sum(msg, dst, N)
    return _silu(x @ u_w + agg)
```

```asm
; @launch grid=(256,1,1) block=(512,1,1) lds=150528
.amdgcn_target "amdgcn-amd-amdhsa--gfx950"
.text
.globl standalone__edge_featured_mpnn_egc__graph_kernel
.p2align 8
.type standalone__edge_featured_mpnn_egc__graph_kernel,@function
standalone__edge_featured_mpnn_egc__graph_kernel:
    s_load_dwordx16 s[36:51], s[0:1], 0
    s_load_dwordx4 s[52:55], s[0:1], 64
    v_readfirstlane_b32 s18, v0
    s_getpc_b64 s[56:57]
F_PC0:
    s_lshr_b32 s22, s2, 3
    s_lshl_b32 s20, s22, 9
    s_add_u32 s20, s20, s18
    s_and_b32 s20, s20, 0x3fff
    s_min_u32 s21, s20, K_END - F_PC0
    v_mov_b32 v9, s21
    s_mov_b64 exec, 1
    global_load_dword v51, v9, s[56:57]
    s_mov_b64 exec, -1
    s_cmp_ge_u32 s2, 256
    s_cbranch_scc1 K_END
    v_lshlrev_b32 v23, 4, v0
    s_min_u32 s31, s2, 249
    s_mul_i32 s31, s31, 10240
    v_add_u32 v3, s31, v23
    s_add_u32 s31, s31, 8192
    v_lshl_add_u32 v4, v0, 2, s31
    v_mov_b32 v140, 0
    v_mov_b32 v141, 0
    v_mov_b32 v142, 0
    v_mov_b32 v143, 0
    v_and_b32 v11, 0x7f0, v23
    ds_write_b128 v11, v[140:143] offset:0
    s_lshr_b32 s18, s18, 6
    s_mov_b32 s21, 4554752
    s_and_b32 s23, s20, 0x7ff
    s_add_u32 s23, s23, 0x4000
    s_and_b32 s29, s20, 0x1fff
    s_waitcnt lgkmcnt(0)
    global_load_dwordx4 v[168:171], v3, s[42:43]
    global_load_dword v172, v4, s[42:43]
    s_load_dword s88, s[54:55], s21
    s_and_b32 s21, s2, 7
    s_lshl_b32 s21, s21, 5
    s_add_u32 s3, s21, s22
    s_mul_i32 s25, s3, 625
    s_add_u32 s25, s25, 15
    s_add_u32 s32, s25, 625
    s_lshr_b32 s25, s25, 4
    s_lshr_b32 s32, s32, 4
    s_sub_u32 s32, s32, s25
    s_lshl_b32 s25, s25, 7
    s_mov_b32 s4, s36
    s_mov_b32 s5, s37
    s_mov_b32 s6, 1280000
    s_mov_b32 s7, 0x20000
    s_barrier
    global_load_dwordx4 v[176:179], v3, s[40:41]
    global_load_dword v180, v4, s[40:41]
    v_bfe_u32 v1, v0, 5, 1
    v_and_b32 v10, 31, v0
    v_lshlrev_b32 v1, 4, v1
    v_min_u32 v10, 9, v10
    v_lshl_add_u32 v7, v10, 7, v1
    s_lshr_b32 s29, s18, 1
    s_mul_i32 s31, s29, 1280
    s_add_u32 s31, s31, s25
    s_mul_i32 s21, s18, 640
    s_add_u32 s21, s21, s25
    v_lshlrev_b32 v9, 7, v10
    s_lshl_b32 s20, s20, 1
    s_and_b32 s58, s20, 0x1fff
    s_cmp_lt_u32 s20, 0x6000
    s_cselect_b64 s[56:57], s[46:47], s[44:45]
    s_cmp_lt_u32 s20, 0x4000
    s_cselect_b64 s[56:57], s[48:49], s[56:57]
    s_cselect_b32 s20, s20, s58
    s_cselect_b32 s23, s23, s58
    v_mov_b32 v11, s20
    v_writelane_b32 v11, s23, 1
    s_mov_b64 exec, 31
    buffer_load_dword v52, v9, s[4:7], s21 offen
    global_load_dword v53, v11, s[56:57]
    s_mov_b64 exec, -1
    v_mov_b32 v136, 0x400ffff
    v_mov_b32 v137, 0x400ffff
    v_mov_b32 v138, 0x400ffff
    v_mov_b32 v139, 0x400ffff
    ds_write_b128 v23, v[136:139] offset:41984
    ds_write_b128 v23, v[136:139] offset:50176
    ds_write_b128 v23, v[136:139] offset:58368
    v_and_b32 v9, 63, v0
    v_mov_b32 v18, 0
    s_mov_b32 s12, s54
    s_mov_b32 s13, s55
    s_mov_b32 s14, 4587520
    s_mov_b32 s15, 0x20000
    s_mov_b32 s27, 0x80000000
    s_mul_i32 s64, s2, 4224
    s_add_u32 s64, s64, 3440640
    s_cmp_ge_u32 s18, 4
    s_cselect_b32 s64, s27, s64
    s_mul_i32 s30, s2, 13696
    s_cmp_ge_u32 s2, 250
    s_cselect_b32 s30, s27, s30
    s_add_u32 s24, s30, 8192
    v_cmp_gt_u32 vcc, 344, v0
    v_mov_b32 v5, 0x40000000
    s_nop 0
    v_cndmask_b32 v5, v5, v23, vcc
    s_mov_b32 s8, s38
    s_mov_b32 s9, s39
    s_mov_b32 s10, 20480000
    s_mov_b32 s11, 0x20000
    s_mov_b32 s16, s50
    s_mov_b32 s17, s51
    s_mov_b32 s60, s48
    s_mov_b32 s61, s49
    s_mov_b32 s62, 18432
    s_mov_b32 s63, 0x20000
    s_lshl_b32 s65, s3, 4
    s_add_u32 s65, s65, 3440640
    v_lshlrev_b32 v2, 4, v9
    s_movk_i32 s26, 128
    s_lshl_b32 s32, s32, 3
    s_lshl_b32 s22, s22, 3
    s_add_u32 s22, s22, s18
    s_mul_i32 s22, s22, 5120
    v_lshl_add_u32 v20, v2, 3, s22
    s_lshl_b32 s59, s18, 10
    s_lshl_b32 s19, s18, 13
    s_add_u32 s19, s19, 84992
    v_and_b32 v10, 7, v0
    v_lshlrev_b32 v10, 4, v10
    v_lshlrev_b32 v11, 2, v1
    v_xor_b32 v28, v10, v11
    v_xor_b32 v29, 16, v28
    v_xor_b32 v30, 32, v28
    v_xor_b32 v31, 48, v28
    v_xor_b32 v8, v10, v1
    v_and_b32 v10, 31, v0
    v_lshlrev_b32 v6, 3, v10
    v_and_b32 v9, 3, v0
    v_lshrrev_b32 v11, 3, v10
    v_and_or_b32 v11, v0, 4, v11
    v_lshl_add_u32 v16, v11, 2, v9
    v_lshlrev_b32 v16, 2, v16
    v_lshl_add_u32 v11, v9, 3, v11
    v_lshl_add_u32 v11, v11, 7, s19
    v_xor_b32 v32, 0, v8
    v_add_u32 v32, v32, v11
    v_xor_b32 v33, 32, v8
    v_add_u32 v33, v33, v11
    v_xor_b32 v34, 64, v8
    v_add_u32 v34, v34, v11
    v_xor_b32 v35, 96, v8
    v_add_u32 v35, v35, v11
    v_bfe_u32 v11, v0, 2, 2
    v_lshlrev_b32 v11, 7, v11
    v_lshl_add_u32 v11, v1, 6, v11
    v_lshl_add_u32 v11, v9, 3, v11
    v_and_b32 v10, 16, v0
    v_lshl_add_u32 v11, v10, 1, v11
    v_add_u32 v19, 66560, v11
    v_lshrrev_b32 v9, 1, v0
    v_and_b32 v22, 1, v0
    v_mul_u32_u24 v13, 13696, v9
    v_mul_u32_u24 v21, 4224, v9
    v_mul_u32_u24 v14, 81920, v9
    v_lshl_add_u32 v13, v22, 4, v13
    v_lshl_add_u32 v21, v22, 3, v21
    v_mul_u32_u24 v22, 3, v22
    v_mov_b32 v15, 4
    s_mov_b32 s20, 214749
    s_movk_i32 s23, 625
    v_lshlrev_b32 v10, 16, v0
    v_lshlrev_b32 v11, 14, v0
    v_add_u32 v11, 0x2000000, v11
    s_add_u32 m0, s59, 84992
    s_waitcnt vmcnt(4)
    v_mul_u32_u24 v184, s20, v168
    v_lshrrev_b32 v184, 23, v184
    v_mad_u32_u24 v192, v184, s23, 15
    v_lshlrev_b32 v184, 2, v184
    ds_add_rtn_u32 v200, v184, v15 offset:1024
    v_mul_u32_u24 v185, s20, v169
    v_lshrrev_b32 v185, 23, v185
    v_mad_u32_u24 v193, v185, s23, 15
    v_lshlrev_b32 v185, 2, v185
    ds_add_rtn_u32 v201, v185, v15 offset:1024
    v_mul_u32_u24 v186, s20, v170
    v_lshrrev_b32 v186, 23, v186
    v_mad_u32_u24 v194, v186, s23, 15
    v_lshlrev_b32 v186, 2, v186
    ds_add_rtn_u32 v202, v186, v15 offset:1024
    v_mul_u32_u24 v187, s20, v171
    v_lshrrev_b32 v187, 23, v187
    v_mad_u32_u24 v195, v187, s23, 15
    v_lshlrev_b32 v187, 2, v187
    ds_add_rtn_u32 v203, v187, v15 offset:1024
    v_mul_u32_u24 v188, s20, v172
    v_lshrrev_b32 v188, 23, v188
    v_mad_u32_u24 v196, v188, s23, 15
    v_lshlrev_b32 v188, 2, v188
    ds_add_rtn_u32 v204, v188, v15 offset:1024
    global_load_lds_dwordx4 v23, s[48:49]
    s_add_u32 m0, s59, 93184
    s_nop 0
    global_load_lds_dwordx4 v23, s[44:45]
    s_add_u32 m0, s59, 101376
    s_cmp_lt_u32 s18, 5
    s_cselect_b32 s31, s25, s27
    buffer_load_dwordx4 v23, s[4:7], s31 offen lds
    s_waitcnt lgkmcnt(0)
    s_barrier
    ds_read_b128 v[224:227], v2 offset:1024
    s_mul_i32 s88, s88, 0x9e3779b1
    s_add_u32 s88, s88, 0x7f4a7c15
    s_mul_i32 s89, s88, 0x85ebca6b
    v_lshrrev_b32 v192, 4, v192
    v_sub_u32 v192, v168, v192
    v_lshrrev_b32 v193, 4, v193
    v_sub_u32 v193, v169, v193
    v_lshrrev_b32 v194, 4, v194
    v_sub_u32 v194, v170, v194
    v_lshrrev_b32 v195, 4, v195
    v_sub_u32 v195, v171, v195
    v_lshrrev_b32 v196, 4, v196
    v_sub_u32 v196, v172, v196
    s_waitcnt lgkmcnt(0)
    v_add_u32 v229, v224, v225
    v_add_u32 v230, v229, v226
    v_add_u32 v231, v230, v227
    v_mov_b32 v228, v231
    v_lshl_or_b32 v192, v192, 26, v10
    v_lshl_or_b32 v193, v193, 26, v10
    v_add_u32_dpp v228, v228, v228 row_shr:1 row_mask:0xf bank_mask:0xf bound_ctrl:0
    v_lshl_or_b32 v194, v194, 26, v10
    v_lshl_or_b32 v195, v195, 26, v10
    v_add_u32_dpp v228, v228, v228 row_shr:2 row_mask:0xf bank_mask:0xf bound_ctrl:0
    v_lshl_or_b32 v196, v196, 26, v11
    v_add_u32 v193, 16384, v193
    v_add_u32_dpp v228, v228, v228 row_shr:4 row_mask:0xf bank_mask:0xf bound_ctrl:0
    v_add_u32 v194, 32768, v194
    v_add_u32 v195, 49152, v195
    v_add_u32_dpp v228, v228, v228 row_shr:8 row_mask:0xf bank_mask:0xf bound_ctrl:0
    v_lshlrev_b32 v10, 2, v0
    v_and_b32 v10, 0x3fc, v10
    v_add_u32_dpp v228, v228, v228 row_bcast:15 row_mask:0xa bank_mask:0xf
    v_mov_b32 v59, s89
    s_movk_i32 s21, 21846
    v_add_u32_dpp v228, v228, v228 row_bcast:31 row_mask:0xc bank_mask:0xf
    v_sub_u32 v232, v228, v231
    v_add_u32 v233, v232, v224
    v_add_u32 v234, v232, v229
    v_add_u32 v235, v232, v230
    ds_write_b128 v2, v[232:235] offset:2048
    ds_read2st64_b32 v[56:57], v10 offset0:4 offset1:8
    ds_read_b32 v168, v184 offset:2048
    ds_read_b32 v169, v185 offset:2048
    ds_read_b32 v170, v186 offset:2048
    ds_read_b32 v171, v187 offset:2048
    ds_read_b32 v172, v188 offset:2048
    s_mov_b32 exec_lo, 0xff
    s_mov_b32 exec_hi, 0x0
    buffer_load_dword v55, v20, s[4:7], 0 offen
    s_mov_b64 exec, -1
    s_waitcnt lgkmcnt(5)
    v_lshl_or_b32 v56, v56, 16, v57
    s_cmp_lt_u32 s2, 250
    s_cselect_b32 s22, -1, 0
    v_mov_b32 v57, s88
    v_and_b32 v56, s22, v56
    v_mov_b32 v58, v56
    buffer_store_dwordx4 v[56:59], v23, s[12:15], s64 offen sc1
    s_waitcnt vmcnt(7)
    v_or_b32 v192, v176, v192
    v_or_b32 v193, v177, v193
    v_or_b32 v194, v178, v194
    v_or_b32 v195, v179, v195
    v_or_b32 v196, v180, v196
    s_waitcnt lgkmcnt(0)
    v_add_u32 v168, v168, v200
    v_mul_u32_u24 v184, s21, v168
    v_lshrrev_b32 v184, 18, v184
    v_lshl_add_u32 v168, v184, 2, v168
    ds_write_b32 v168, v192 offset:3072
    v_add_u32 v169, v169, v201
    v_mul_u32_u24 v185, s21, v169
    v_lshrrev_b32 v185, 18, v185
    v_lshl_add_u32 v169, v185, 2, v169
    ds_write_b32 v169, v193 offset:3072
    v_add_u32 v170, v170, v202
    v_mul_u32_u24 v186, s21, v170
    v_lshrrev_b32 v186, 18, v186
    v_lshl_add_u32 v170, v186, 2, v170
    ds_write_b32 v170, v194 offset:3072
    v_add_u32 v171, v171, v203
    v_mul_u32_u24 v187, s21, v171
    v_lshrrev_b32 v187, 18, v187
    v_lshl_add_u32 v171, v187, 2, v171
    ds_write_b32 v171, v195 offset:3072
    v_add_u32 v172, v172, v204
    v_mul_u32_u24 v188, s21, v172
    v_lshrrev_b32 v188, 18, v188
    v_lshl_add_u32 v172, v188, 2, v172
    ds_write_b32 v172, v196 offset:3072
    s_waitcnt lgkmcnt(0)
    s_barrier
    ds_read_b96 v[224:226], v23 offset:3072
    ds_read_b96 v[228:230], v23 offset:11264
    v_mov_b32 v227, s88
    v_mov_b32 v231, s88
    s_and_b32 s20, s18, 1
    s_lshl_b32 s23, s20, 6
    s_waitcnt lgkmcnt(1)
    buffer_store_dwordx4 v[224:227], v23, s[12:15], s30 offen sc1
    s_waitcnt lgkmcnt(0)
    buffer_store_dwordx4 v[228:231], v5, s[12:15], s24 offen sc1
    s_add_u32 m0, s59, 76800
    s_movk_i32 s57, 0x2000
    s_movk_i32 s58, 0x4000
    buffer_load_dwordx4 v[120:123], v23, s[60:63], s57 offen
    buffer_load_dwordx4 v[124:127], v23, s[60:63], s58 offen
    global_load_lds_dwordx4 v23, s[46:47]
    v_add_u32 v9, s23, v19
    s_waitcnt vmcnt(7)
    s_barrier
    buffer_load_dwordx2 v[44:45], v21, s[12:15], s65 offen sc1
    s_mul_i32 s31, s29, 1280
    s_add_u32 s31, s31, 101376
    v_add_u32 v7, s31, v7
    ds_read_b128 v[104:107], v7 offset:0
    ds_read_b128 v[108:111], v7 offset:32
    ds_read_b128 v[112:115], v7 offset:64
    ds_read_b128 v[116:119], v7 offset:96
    ds_read_b64_tr_b16 v[64:65], v9 offset:18432
    ds_read_b64_tr_b16 v[66:67], v9 offset:18944
    ds_read_b64_tr_b16 v[68:69], v9 offset:20480
    ds_read_b64_tr_b16 v[70:71], v9 offset:20992
    ds_read_b64_tr_b16 v[72:73], v9 offset:22528
    ds_read_b64_tr_b16 v[74:75], v9 offset:23040
    ds_read_b64_tr_b16 v[76:77], v9 offset:24576
    ds_read_b64_tr_b16 v[78:79], v9 offset:25088
    ds_read_b64_tr_b16 v[80:81], v9 offset:26624
    ds_read_b64_tr_b16 v[82:83], v9 offset:27136
    ds_read_b64_tr_b16 v[84:85], v9 offset:28672
    ds_read_b64_tr_b16 v[86:87], v9 offset:29184
    ds_read_b64_tr_b16 v[88:89], v9 offset:30720
    ds_read_b64_tr_b16 v[90:91], v9 offset:31232
    ds_read_b64_tr_b16 v[92:93], v9 offset:32768
    ds_read_b64_tr_b16 v[94:95], v9 offset:33280
    s_mul_i32 s21, s29, 10240
    v_lshl_add_u32 v8, v1, 8, v6
    v_lshl_add_u32 v9, v1, 6, v6
    s_lshl_b32 s22, s20, 2
    s_add_u32 s22, s22, s21
    s_lshl_b32 s23, s20, 8
    s_add_u32 s23, s23, s21
    v_cmp_ne_u32 s[68:69], 0, v22
    s_waitcnt lgkmcnt(8)
    v_mfma_f32_32x32x16_bf16 v[136:151], v[104:107], v[64:67], 0
    v_mfma_f32_32x32x16_bf16 v[136:151], v[108:111], v[68:71], v[136:151]
    v_mfma_f32_32x32x16_bf16 v[136:151], v[112:115], v[72:75], v[136:151]
    v_mfma_f32_32x32x16_bf16 v[136:151], v[116:119], v[76:79], v[136:151]
    s_waitcnt lgkmcnt(0)
    v_mfma_f32_32x32x16_bf16 v[152:167], v[104:107], v[80:83], 0
    v_mfma_f32_32x32x16_bf16 v[152:167], v[108:111], v[84:87], v[152:167]
    v_mfma_f32_32x32x16_bf16 v[152:167], v[112:115], v[88:91], v[152:167]
    v_mfma_f32_32x32x16_bf16 v[152:167], v[116:119], v[92:95], v[152:167]
    v_add_u32 v40, s22, v8
    v_add_u32 v41, s22, v9
    v_add_u32 v42, s23, v8
    v_add_u32 v43, s23, v9
    v_cndmask_b32 v10, v57, v59, s[68:69]
    s_mov_b32 s99, 0x400000
    s_mov_b32 s23, 36
    s_mov_b32 s24, 1
    s_mov_b32 s33, 1
    s_mov_b32 s28, 0xfc003fff
F_POLL:
    s_waitcnt vmcnt(0)
    v_cmp_ne_u32 vcc, v45, v10
    s_cmp_eq_u64 vcc, 0
    s_cbranch_scc1 F_GOT
    s_sub_u32 s99, s99, 1
    s_cmp_eq_u32 s99, 0
    s_cbranch_scc1 F_LOST
    s_lshr_b64 s[56:57], vcc, 1
    s_or_b64 s[56:57], s[56:57], vcc
    s_andn2_b64 s[56:57], s[56:57], s[68:69]
    s_lshl_b64 s[58:59], s[56:57], 1
    s_or_b64 exec, s[56:57], s[58:59]
    buffer_load_dwordx2 v[44:45], v21, s[12:15], s65 offen sc1
    s_branch F_POLL
F_LOST:
    v_mov_b32 v44, 0
F_GOT:
    s_mov_b64 exec, -1
    v_bfe_u32 v11, v44, 2, 14
    v_lshrrev_b32 v9, 18, v44
    v_mul_u32_u24 v8, 21846, v11
    v_cmp_ne_u32 vcc, 0, v9
    v_lshrrev_b32 v8, 16, v8
    v_mad_i32_i24 v24, v8, -3, v11
    v_lshl_add_u32 v13, v8, 4, v13
    v_cndmask_b32 v24, 0, v24, vcc
    v_add_u32 v10, v9, v24
    v_sub_u32 v12, v10, v22
    v_sub_u32 v24, v24, v22
    s_branch K_SORT
K_ROUND:
    s_barrier
    v_mov_b32 v204, 0
    v_mov_b32 v205, 0
    v_mov_b32 v206, 0
    v_mov_b32 v207, 0
    v_and_b32 v11, 0x3f0, v23
    ds_write_b128 v11, v[204:207] offset:0
    v_mov_b32 v200, 0x400ffff
    v_mov_b32 v201, 0x400ffff
    v_mov_b32 v202, 0x400ffff
    v_mov_b32 v203, 0x400ffff
    ds_write_b128 v23, v[200:203] offset:41984
    ds_write_b128 v23, v[200:203] offset:50176
    ds_write_b128 v23, v[200:203] offset:58368
    v_subrev_u32 v12, s3, v12
    v_subrev_u32 v24, s3, v24
    s_cmp_lg_u32 s3, 0
    s_cselect_b32 s3, 32, 0
    v_add_u32 v13, s3, v13
    s_mov_b32 s3, 6
    s_waitcnt lgkmcnt(0)
    s_barrier
K_SORT:
    v_sub_u32 v11, s23, v22
    v_min_i32 v11, v12, v11
    s_mov_b32 s99, 0x400000
    v_cmp_lt_i32 s[34:35], 0, v11
    v_cmp_lt_i32 s[40:41], 6, v11
    v_cmp_lt_i32 s[46:47], 12, v11
    v_cmp_lt_i32 s[52:53], 18, v11
    v_cmp_lt_i32 s[58:59], 24, v11
    v_cmp_lt_i32 s[64:65], 30, v11
    s_and_b64 exec, s[34:35], s[34:35]
    s_cbranch_scc0 K_LD
    buffer_load_dwordx4 v[224:227], v13, s[12:15], 0 offen offset:0
    s_and_b64 exec, s[40:41], s[40:41]
    s_cbranch_scc0 K_LD
    buffer_load_dwordx4 v[228:231], v13, s[12:15], 0 offen offset:32
    s_and_b64 exec, s[46:47], s[46:47]
    s_cbranch_scc0 K_LD
    buffer_load_dwordx4 v[232:235], v13, s[12:15], 0 offen offset:64
    s_and_b64 exec, s[52:53], s[52:53]
    s_cbranch_scc0 K_LD
    buffer_load_dwordx4 v[236:239], v13, s[12:15], 0 offen offset:96
    s_and_b64 exec, s[58:59], s[58:59]
    s_cbranch_scc0 K_LD
    buffer_load_dwordx4 v[240:243], v13, s[12:15], 0 offen offset:128
    s_and_b64 exec, s[64:65], s[64:65]
    s_cbranch_scc0 K_LD
    buffer_load_dwordx4 v[244:247], v13, s[12:15], 0 offen offset:160
K_LD:
    s_mov_b64 exec, -1
    v_cmp_lt_i32 s[36:37], 1, v11
    v_cmp_lt_i32 s[38:39], 2, v11
    v_cmp_lt_i32 s[42:43], 7, v11
    v_cmp_lt_i32 s[44:45], 8, v11
    v_cmp_lt_i32 s[48:49], 13, v11
    v_cmp_lt_i32 s[50:51], 14, v11
    v_cmp_lt_i32 s[54:55], 19, v11
    v_cmp_lt_i32 s[56:57], 20, v11
    v_cmp_lt_i32 s[60:61], 25, v11
    v_cmp_lt_i32 s[62:63], 26, v11
    v_cmp_lt_i32 s[66:67], 31, v11
    v_cmp_lt_i32 s[68:69], 32, v11
    s_lshl_b32 s21, s18, 7
    v_bfe_u32 v3, v0, 3, 3
    v_lshlrev_b32 v3, 4, v3
    s_add_u32 s22, s21, 41984
    v_add_u32 v3, s22, v3
    v_lshl_add_u32 v5, v1, 2, s22
    s_add_u32 s31, s21, 54272
    v_add_u32 v4, s31, v16
    v_lshrrev_b32 v8, 1, v2
    v_min_u32 v8, 320, v8
    s_cmp_eq_u32 s33, 0
    s_cbranch_scc1 K_VER
    v_cmp_lt_u32 vcc, 36, v10
    s_and_b64 exec, exec, vcc
    ds_max_u32 v18, v10 offset:504
    s_mov_b64 exec, -1
    s_mov_b32 s21, 0xbfb8aa3b
    v_mov_b32 v48, 0
    v_mul_f32 v136, s21, v136
    v_mul_f32 v137, s21, v137
    v_mul_f32 v138, s21, v138
    v_mul_f32 v139, s21, v139
    v_mul_f32 v140, s21, v140
    v_exp_f32 v144, v136
    v_exp_f32 v145, v137
    v_exp_f32 v146, v138
    v_exp_f32 v147, v139
    v_exp_f32 v148, v140
    v_and_b32 v49, 0x7fffffff, v136
    v_max_u32 v48, v48, v49
    ds_write2st64_b32 v40, v144, v136 offset0:4 offset1:5
    v_and_b32 v49, 0x7fffffff, v137
    v_max_u32 v48, v48, v49
    ds_write2st64_b32 v40, v145, v137 offset0:8 offset1:9
    v_and_b32 v49, 0x7fffffff, v138
    v_max_u32 v48, v48, v49
    ds_write2st64_b32 v40, v146, v138 offset0:12 offset1:13
    v_and_b32 v49, 0x7fffffff, v139
    v_max_u32 v48, v48, v49
    ds_write2st64_b32 v40, v147, v139 offset0:16 offset1:17
    v_and_b32 v49, 0x7fffffff, v140
    v_max_u32 v48, v48, v49
    ds_write2st64_b32 v41, v148, v140 offset0:36 offset1:37
    v_cmp_lt_u32 vcc, 0x42700000, v48
    v_cvt_f64_f32 v[168:169], v152
    ds_write_b64 v42, v[168:169] offset:1536
    v_cvt_f64_f32 v[170:171], v153
    ds_write_b64 v42, v[170:171] offset:2560
    v_cvt_f64_f32 v[172:173], v154
    ds_write_b64 v42, v[172:173] offset:3584
    v_cvt_f64_f32 v[174:175], v155
    ds_write_b64 v42, v[174:175] offset:4608
    v_cvt_f64_f32 v[176:177], v156
    ds_write_b64 v43, v[176:177] offset:9728
    s_and_b64 exec, exec, vcc
    ds_write_b32 v18, v15 offset:496
    s_mov_b64 exec, -1
    s_mov_b32 s21, 0xbfb8aa3b
    s_mov_b32 s22, 0xffff0000
    v_add_u32 v50, 66560, v23
    v_lshlrev_b32 v184, 16, v120
    v_and_b32 v185, s22, v120
    v_lshlrev_b32 v186, 16, v121
    v_and_b32 v187, s22, v121
    v_lshlrev_b32 v188, 16, v122
    v_and_b32 v189, s22, v122
    v_lshlrev_b32 v190, 16, v123
    v_and_b32 v191, s22, v123
    v_mul_f32 v184, s21, v184
    v_mul_f32 v185, s21, v185
    v_mul_f32 v186, s21, v186
    v_mul_f32 v187, s21, v187
    v_mul_f32 v188, s21, v188
    v_mul_f32 v189, s21, v189
    v_mul_f32 v190, s21, v190
    v_mul_f32 v191, s21, v191
    v_cvt_pk_bf16_f32 v128, v184, v185
    v_cvt_pk_bf16_f32 v129, v186, v187
    v_cvt_pk_bf16_f32 v130, v188, v189
    v_cvt_pk_bf16_f32 v131, v190, v191
    ds_write_b128 v50, v[128:131] offset:0
    s_cmp_ge_u32 s18, 2
    s_cbranch_scc1 F_BCD
    v_lshlrev_b32 v184, 16, v124
    v_and_b32 v185, s22, v124
    v_lshlrev_b32 v186, 16, v125
    v_and_b32 v187, s22, v125
    v_lshlrev_b32 v188, 16, v126
    v_and_b32 v189, s22, v126
    v_lshlrev_b32 v190, 16, v127
    v_and_b32 v191, s22, v127
    v_mul_f32 v184, s21, v184
    v_mul_f32 v185, s21, v185
    v_mul_f32 v186, s21, v186
    v_mul_f32 v187, s21, v187
    v_mul_f32 v188, s21, v188
    v_mul_f32 v189, s21, v189
    v_mul_f32 v190, s21, v190
    v_mul_f32 v191, s21, v191
    v_cvt_pk_bf16_f32 v132, v184, v185
    v_cvt_pk_bf16_f32 v133, v186, v187
    v_cvt_pk_bf16_f32 v134, v188, v189
    v_cvt_pk_bf16_f32 v135, v190, v191
    ds_write_b128 v50, v[132:135] offset:8192
F_BCD:
K_VER:
    s_mov_b64 s[96:97], 0
    s_waitcnt vmcnt(0)
    v_cmp_ne_u32 vcc, s88, v227
    s_and_b64 vcc, vcc, s[34:35]
    s_or_b64 s[96:97], s[96:97], vcc
    v_cmp_ne_u32 vcc, s88, v231
    s_and_b64 vcc, vcc, s[40:41]
    s_or_b64 s[96:97], s[96:97], vcc
    v_cmp_ne_u32 vcc, s88, v235
    s_and_b64 vcc, vcc, s[46:47]
    s_or_b64 s[96:97], s[96:97], vcc
    v_cmp_ne_u32 vcc, s88, v239
    s_and_b64 vcc, vcc, s[52:53]
    s_or_b64 s[96:97], s[96:97], vcc
    v_cmp_ne_u32 vcc, s88, v243
    s_and_b64 vcc, vcc, s[58:59]
    s_or_b64 s[96:97], s[96:97], vcc
    v_cmp_ne_u32 vcc, s88, v247
    s_and_b64 vcc, vcc, s[64:65]
    s_or_b64 s[96:97], s[96:97], vcc
    s_cbranch_scc0 K_OK
    s_sub_u32 s99, s99, 1
    s_cmp_eq_u32 s99, 0
    s_cbranch_scc1 K_LOST
    s_and_b64 exec, s[34:35], s[34:35]
    s_cbranch_scc0 K_LD2
    buffer_load_dwordx4 v[224:227], v13, s[12:15], 0 offen offset:0 sc1
    s_and_b64 exec, s[40:41], s[40:41]
    s_cbranch_scc0 K_LD2
    buffer_load_dwordx4 v[228:231], v13, s[12:15], 0 offen offset:32 sc1
    s_and_b64 exec, s[46:47], s[46:47]
    s_cbranch_scc0 K_LD2
    buffer_load_dwordx4 v[232:235], v13, s[12:15], 0 offen offset:64 sc1
    s_and_b64 exec, s[52:53], s[52:53]
    s_cbranch_scc0 K_LD2
    buffer_load_dwordx4 v[236:239], v13, s[12:15], 0 offen offset:96 sc1
    s_and_b64 exec, s[58:59], s[58:59]
    s_cbranch_scc0 K_LD2
    buffer_load_dwordx4 v[240:243], v13, s[12:15], 0 offen offset:128 sc1
    s_and_b64 exec, s[64:65], s[64:65]
    s_cbranch_scc0 K_LD2
    buffer_load_dwordx4 v[244:247], v13, s[12:15], 0 offen offset:160 sc1
K_LD2:
    s_mov_b64 exec, -1
    s_branch K_VER
K_LOST:
    s_mov_b64 s[34:35], 0
    s_mov_b64 s[36:37], 0
    s_mov_b64 s[38:39], 0
    s_mov_b64 s[40:41], 0
    s_mov_b64 s[42:43], 0
    s_mov_b64 s[44:45], 0
    s_mov_b64 s[46:47], 0
    s_mov_b64 s[48:49], 0
    s_mov_b64 s[50:51], 0
    s_mov_b64 s[52:53], 0
    s_mov_b64 s[54:55], 0
    s_mov_b64 s[56:57], 0
    s_mov_b64 s[58:59], 0
    s_mov_b64 s[60:61], 0
    s_mov_b64 s[62:63], 0
    s_mov_b64 s[64:65], 0
    s_mov_b64 s[66:67], 0
    s_mov_b64 s[68:69], 0
K_OK:
    v_cmp_ge_i32 vcc, 0, v24
    v_cmp_ge_i32 s[96:97], 1, v24
    s_and_b64 s[34:35], s[34:35], vcc
    s_and_b64 s[36:37], s[36:37], s[96:97]
    s_mov_b32 exec_lo, 0xffffff00
    s_mov_b32 exec_hi, 0x0
    buffer_load_dword v17, v20, s[4:7], 0 offen
    s_mov_b64 exec, -1
    v_and_b32 v200, s28, v224
    v_lshrrev_b32 v136, 23, v200
    v_and_b32 v201, s28, v225
    v_lshrrev_b32 v137, 23, v201
    v_and_b32 v202, s28, v226
    v_lshrrev_b32 v138, 23, v202
    s_mov_b64 exec, s[34:35]
    ds_add_rtn_u32 v168, v136, v15 offset:0
    s_mov_b64 exec, s[36:37]
    ds_add_rtn_u32 v169, v137, v15 offset:0
    s_mov_b64 exec, s[38:39]
    ds_add_rtn_u32 v170, v138, v15 offset:0
    s_mov_b64 exec, -1
    v_bfe_u32 v224, v224, 14, 12
    v_lshl_add_u32 v224, v224, 5, v14
    v_bfe_u32 v225, v225, 14, 12
    v_lshl_add_u32 v225, v225, 5, v14
    v_bfe_u32 v226, v226, 14, 12
    v_lshl_add_u32 v226, v226, 5, v14
    v_and_b32 v203, s28, v228
    v_lshrrev_b32 v139, 23, v203
    v_and_b32 v204, s28, v229
    v_lshrrev_b32 v140, 23, v204
    v_and_b32 v205, s28, v230
    v_lshrrev_b32 v141, 23, v205
    s_mov_b64 exec, s[40:41]
    ds_add_rtn_u32 v171, v139, v15 offset:0
    s_mov_b64 exec, s[42:43]
    ds_add_rtn_u32 v172, v140, v15 offset:0
    s_mov_b64 exec, s[44:45]
    ds_add_rtn_u32 v173, v141, v15 offset:0
    s_mov_b64 exec, -1
    s_cmp_eq_u64 s[46:47], 0
    s_cbranch_scc1 K_P1D
    v_and_b32 v206, s28, v232
    v_lshrrev_b32 v142, 23, v206
    v_and_b32 v207, s28, v233
    v_lshrrev_b32 v143, 23, v207
    v_and_b32 v208, s28, v234
    v_lshrrev_b32 v144, 23, v208
    s_mov_b64 exec, s[46:47]
    ds_add_rtn_u32 v174, v142, v15 offset:0
    s_mov_b64 exec, s[48:49]
    ds_add_rtn_u32 v175, v143, v15 offset:0
    s_mov_b64 exec, s[50:51]
    ds_add_rtn_u32 v176, v144, v15 offset:0
    s_mov_b64 exec, -1
    s_cmp_eq_u64 s[52:53], 0
    s_cbranch_scc1 K_P1D
    v_and_b32 v209, s28, v236
    v_lshrrev_b32 v145, 23, v209
    v_and_b32 v210, s28, v237
    v_lshrrev_b32 v146, 23, v210
    v_and_b32 v211, s28, v238
    v_lshrrev_b32 v147, 23, v211
    s_mov_b64 exec, s[52:53]
    ds_add_rtn_u32 v177, v145, v15 offset:0
    s_mov_b64 exec, s[54:55]
    ds_add_rtn_u32 v178, v146, v15 offset:0
    s_mov_b64 exec, s[56:57]
    ds_add_rtn_u32 v179, v147, v15 offset:0
    s_mov_b64 exec, -1
    v_bfe_u32 v236, v236, 14, 12
    v_lshl_add_u32 v236, v236, 5, v14
    v_bfe_u32 v237, v237, 14, 12
    v_lshl_add_u32 v237, v237, 5, v14
    v_bfe_u32 v238, v238, 14, 12
    v_lshl_add_u32 v238, v238, 5, v14
    s_cmp_eq_u64 s[58:59], 0
    s_cbranch_scc1 K_P1D
    v_and_b32 v212, s28, v240
    v_lshrrev_b32 v148, 23, v212
    v_and_b32 v213, s28, v241
    v_lshrrev_b32 v149, 23, v213
    v_and_b32 v214, s28, v242
    v_lshrrev_b32 v150, 23, v214
    s_mov_b64 exec, s[58:59]
    ds_add_rtn_u32 v180, v148, v15 offset:0
    s_mov_b64 exec, s[60:61]
    ds_add_rtn_u32 v181, v149, v15 offset:0
    s_mov_b64 exec, s[62:63]
    ds_add_rtn_u32 v182, v150, v15 offset:0
    s_mov_b64 exec, -1
    v_bfe_u32 v240, v240, 14, 12
    v_lshl_add_u32 v240, v240, 5, v14
    v_bfe_u32 v241, v241, 14, 12
    v_lshl_add_u32 v241, v241, 5, v14
    v_bfe_u32 v242, v242, 14, 12
    v_lshl_add_u32 v242, v242, 5, v14
    s_cmp_eq_u64 s[64:65], 0
    s_cbranch_scc1 K_P1D
    v_and_b32 v215, s28, v244
    v_lshrrev_b32 v151, 23, v215
    v_and_b32 v216, s28, v245
    v_lshrrev_b32 v152, 23, v216
    v_and_b32 v217, s28, v246
    v_lshrrev_b32 v153, 23, v217
    s_mov_b64 exec, s[64:65]
    ds_add_rtn_u32 v183, v151, v15 offset:0
    s_mov_b64 exec, s[66:67]
    ds_add_rtn_u32 v184, v152, v15 offset:0
    s_mov_b64 exec, s[68:69]
    ds_add_rtn_u32 v185, v153, v15 offset:0
    s_mov_b64 exec, -1
    v_bfe_u32 v244, v244, 14, 12
    v_lshl_add_u32 v244, v244, 5, v14
    v_bfe_u32 v245, v245, 14, 12
    v_lshl_add_u32 v245, v245, 5, v14
    v_bfe_u32 v246, v246, 14, 12
    v_lshl_add_u32 v246, v246, 5, v14
K_P1D:
    s_waitcnt lgkmcnt(0)
    s_barrier
    ds_read_b32 v10, v8 offset:0
    ds_read_b128 v[44:47], v18 offset:496
    s_mov_b32 s31, 0xc000000
    v_cmp_gt_u32 vcc, s31, v200
    v_cmp_gt_u32 s[96:97], s31, v201
    v_cmp_gt_u32 s[100:101], s31, v202
    s_and_b64 exec, vcc, s[34:35]
    s_cbranch_scc0 K_EP0
    buffer_load_dword v17, v224, s[8:11], 0 offen
K_EP0:
    s_and_b64 exec, s[96:97], s[36:37]
    s_cbranch_scc0 K_EP1
    buffer_load_dword v17, v225, s[8:11], 0 offen
K_EP1:
    s_and_b64 exec, s[100:101], s[38:39]
    s_cbranch_scc0 K_EP2
    buffer_load_dword v17, v226, s[8:11], 0 offen
K_EP2:
    s_mov_b64 exec, -1
    s_waitcnt lgkmcnt(0)
    v_and_b32 v9, -64, v10
    v_and_b32 v10, 63, v10
    v_add_u32 v10, 12, v10
    v_and_b32 v10, -16, v10
    v_lshl_or_b32 v10, v10, 16, v9
    v_mov_b32 v11, v10
    v_bfe_u32 v228, v228, 14, 12
    v_bfe_u32 v229, v229, 14, 12
    v_add_u32_dpp v11, v11, v11 row_shr:1 row_mask:0xf bank_mask:0xf bound_ctrl:0
    v_bfe_u32 v230, v230, 14, 12
    v_bfe_u32 v232, v232, 14, 12
    v_add_u32_dpp v11, v11, v11 row_shr:2 row_mask:0xf bank_mask:0xf bound_ctrl:0
    v_bfe_u32 v233, v233, 14, 12
    v_bfe_u32 v234, v234, 14, 12
    v_add_u32_dpp v11, v11, v11 row_shr:4 row_mask:0xf bank_mask:0xf bound_ctrl:0
    v_lshl_add_u32 v228, v228, 5, v14
    v_lshl_add_u32 v229, v229, 5, v14
    v_add_u32_dpp v11, v11, v11 row_shr:8 row_mask:0xf bank_mask:0xf bound_ctrl:0
    v_lshl_add_u32 v230, v230, 5, v14
    v_lshl_add_u32 v232, v232, 5, v14
    v_add_u32_dpp v11, v11, v11 row_bcast:15 row_mask:0xa bank_mask:0xf
    v_lshl_add_u32 v233, v233, 5, v14
    v_lshl_add_u32 v234, v234, 5, v14
    v_add_u32_dpp v11, v11, v11 row_bcast:31 row_mask:0xc bank_mask:0xf
    s_nop 0
    v_readlane_b32 s21, v11, 63
    v_readlane_b32 s22, v11, 3
    v_sub_u32 v11, v11, v10
    s_lshr_b32 s29, s21, 16
    s_add_u32 s29, s29, 63
    s_and_b32 s29, s29, -64
    s_and_b32 s22, s22, 0xffff
    v_lshrrev_b32 v10, 16, v11
    v_and_b32 v11, 0xffff, v11
    v_sub_u32 v10, v10, v9
    v_lshl_or_b32 v11, v9, 16, v11
    v_add_u32 v10, s22, v10
    s_mov_b32 exec_lo, 0xfffffff0
    v_add_u32 v11, s29, v11
    s_mov_b64 exec, -1
    ds_write2_b32 v8, v11, v10 offset0:128 offset1:129
    ds_read_b64 v[64:65], v136 offset:512
    ds_read_b64 v[66:67], v137 offset:512
    ds_read_b64 v[68:69], v138 offset:512
    ds_read_b64 v[70:71], v139 offset:512
    ds_read_b64 v[72:73], v140 offset:512
    ds_read_b64 v[74:75], v141 offset:512
    s_cmp_eq_u64 s[46:47], 0
    s_cbranch_scc1 K_P2A
    ds_read_b64 v[76:77], v142 offset:512
    ds_read_b64 v[78:79], v143 offset:512
    ds_read_b64 v[80:81], v144 offset:512
    s_cmp_eq_u64 s[52:53], 0
    s_cbranch_scc1 K_P2A
    ds_read_b64 v[82:83], v145 offset:512
    ds_read_b64 v[84:85], v146 offset:512
    ds_read_b64 v[86:87], v147 offset:512
    s_cmp_eq_u64 s[58:59], 0
    s_cbranch_scc1 K_P2A
    ds_read_b64 v[88:89], v148 offset:512
    ds_read_b64 v[90:91], v149 offset:512
    ds_read_b64 v[92:93], v150 offset:512
    s_cmp_eq_u64 s[64:65], 0
    s_cbranch_scc1 K_P2A
    ds_read_b64 v[94:95], v151 offset:512
    ds_read_b64 v[96:97], v152 offset:512
    ds_read_b64 v[98:99], v153 offset:512
K_P2A:
    s_cmp_eq_u32 s33, 0
    s_cbranch_scc1 K_CHK
    v_readfirstlane_b32 s30, v44
    v_readfirstlane_b32 s31, v46
    s_mov_b32 s33, 0
    s_and_b32 s20, s21, 0xffff
    s_add_u32 s20, s20, s29
    s_cmp_gt_u32 s20, 12288
    s_cselect_b32 s20, 36, 0
    s_max_u32 s31, s20, s31
    s_cmp_eq_u32 s31, 0
    s_cbranch_scc1 K_CHK
    s_add_u32 s24, s31, 5
    s_mul_i32 s24, s24, 10923
    s_lshr_b32 s24, s24, 16
    s_mov_b32 s23, 6
    s_mov_b32 s3, 0
    s_waitcnt lgkmcnt(0)
    s_branch K_ROUND
K_CHK:
    s_mov_b32 s31, 0xc000000
    v_cmp_gt_u32 vcc, s31, v203
    v_cmp_gt_u32 s[96:97], s31, v204
    v_cmp_gt_u32 s[100:101], s31, v205
    s_and_b64 exec, vcc, s[40:41]
    s_cbranch_scc0 K_EP3
    buffer_load_dword v17, v228, s[8:11], 0 offen
K_EP3:
    s_and_b64 exec, s[96:97], s[42:43]
    s_cbranch_scc0 K_EP4
    buffer_load_dword v17, v229, s[8:11], 0 offen
K_EP4:
    s_and_b64 exec, s[100:101], s[44:45]
    s_cbranch_scc0 K_EP5
    buffer_load_dword v17, v230, s[8:11], 0 offen
K_EP5:
    s_mov_b64 exec, -1
    s_mov_b32 s31, 0xc000000
    v_cmp_gt_u32 vcc, s31, v206
    v_cmp_gt_u32 s[96:97], s31, v207
    v_cmp_gt_u32 s[100:101], s31, v208
    s_and_b64 exec, vcc, s[46:47]
    s_cbranch_scc0 K_EP6
    buffer_load_dword v17, v232, s[8:11], 0 offen
K_EP6:
    s_and_b64 exec, s[96:97], s[48:49]
    s_cbranch_scc0 K_EP7
    buffer_load_dword v17, v233, s[8:11], 0 offen
K_EP7:
    s_and_b64 exec, s[100:101], s[50:51]
    s_cbranch_scc0 K_EP8
    buffer_load_dword v17, v234, s[8:11], 0 offen
K_EP8:
    s_mov_b64 exec, -1
    s_waitcnt lgkmcnt(0)
    v_cmp_lt_u32_sdwa vcc, v168, v64 src0_sel:DWORD src1_sel:WORD_1
    v_cmp_lt_u32_sdwa s[96:97], v169, v66 src0_sel:DWORD src1_sel:WORD_1
    v_cmp_lt_u32_sdwa s[100:101], v170, v68 src0_sel:DWORD src1_sel:WORD_1
    v_cndmask_b32 v64, v65, v64, vcc
    v_cndmask_b32 v66, v67, v66, s[96:97]
    v_cndmask_b32 v68, v69, v68, s[100:101]
    v_add_u32_sdwa v64, v64, v168 dst_sel:WORD_0 dst_unused:UNUSED_PAD src0_sel:DWORD src1_sel:DWORD
    v_add_u32_sdwa v66, v66, v169 dst_sel:WORD_0 dst_unused:UNUSED_PAD src0_sel:DWORD src1_sel:DWORD
    v_add_u32_sdwa v68, v68, v170 dst_sel:WORD_0 dst_unused:UNUSED_PAD src0_sel:DWORD src1_sel:DWORD
    s_mov_b64 exec, s[34:35]
    ds_write2st64_b32 v64, v200, v224 offset0:164 offset1:212
    s_mov_b64 exec, s[36:37]
    ds_write2st64_b32 v66, v201, v225 offset0:164 offset1:212
    s_mov_b64 exec, s[38:39]
    ds_write2st64_b32 v68, v202, v226 offset0:164 offset1:212
    s_mov_b64 exec, -1
    v_cmp_lt_u32_sdwa vcc, v171, v70 src0_sel:DWORD src1_sel:WORD_1
    v_cmp_lt_u32_sdwa s[96:97], v172, v72 src0_sel:DWORD src1_sel:WORD_1
    v_cmp_lt_u32_sdwa s[100:101], v173, v74 src0_sel:DWORD src1_sel:WORD_1
    v_cndmask_b32 v70, v71, v70, vcc
    v_cndmask_b32 v72, v73, v72, s[96:97]
    v_cndmask_b32 v74, v75, v74, s[100:101]
    v_add_u32_sdwa v70, v70, v171 dst_sel:WORD_0 dst_unused:UNUSED_PAD src0_sel:DWORD src1_sel:DWORD
    v_add_u32_sdwa v72, v72, v172 dst_sel:WORD_0 dst_unused:UNUSED_PAD src0_sel:DWORD src1_sel:DWORD
    v_add_u32_sdwa v74, v74, v173 dst_sel:WORD_0 dst_unused:UNUSED_PAD src0_sel:DWORD src1_sel:DWORD
    s_mov_b64 exec, s[40:41]
    ds_write2st64_b32 v70, v203, v228 offset0:164 offset1:212
    s_mov_b64 exec, s[42:43]
    ds_write2st64_b32 v72, v204, v229 offset0:164 offset1:212
    s_mov_b64 exec, s[44:45]
    ds_write2st64_b32 v74, v205, v230 offset0:164 offset1:212
    s_mov_b64 exec, -1
    s_cmp_eq_u64 s[46:47], 0
    s_cbranch_scc1 K_P2D
    v_cmp_lt_u32_sdwa vcc, v174, v76 src0_sel:DWORD src1_sel:WORD_1
    v_cmp_lt_u32_sdwa s[96:97], v175, v78 src0_sel:DWORD src1_sel:WORD_1
    v_cmp_lt_u32_sdwa s[100:101], v176, v80 src0_sel:DWORD src1_sel:WORD_1
    v_cndmask_b32 v76, v77, v76, vcc
    v_cndmask_b32 v78, v79, v78, s[96:97]
    v_cndmask_b32 v80, v81, v80, s[100:101]
    v_add_u32_sdwa v76, v76, v174 dst_sel:WORD_0 dst_unused:UNUSED_PAD src0_sel:DWORD src1_sel:DWORD
    v_add_u32_sdwa v78, v78, v175 dst_sel:WORD_0 dst_unused:UNUSED_PAD src0_sel:DWORD src1_sel:DWORD
    v_add_u32_sdwa v80, v80, v176 dst_sel:WORD_0 dst_unused:UNUSED_PAD src0_sel:DWORD src1_sel:DWORD
    s_mov_b64 exec, s[46:47]
    ds_write2st64_b32 v76, v206, v232 offset0:164 offset1:212
    s_mov_b64 exec, s[48:49]
    ds_write2st64_b32 v78, v207, v233 offset0:164 offset1:212
    s_mov_b64 exec, s[50:51]
    ds_write2st64_b32 v80, v208, v234 offset0:164 offset1:212
    s_mov_b64 exec, -1
    s_cmp_eq_u64 s[52:53], 0
    s_cbranch_scc1 K_P2D
    v_cmp_lt_u32_sdwa vcc, v177, v82 src0_sel:DWORD src1_sel:WORD_1
    v_cmp_lt_u32_sdwa s[96:97], v178, v84 src0_sel:DWORD src1_sel:WORD_1
    v_cmp_lt_u32_sdwa s[100:101], v179, v86 src0_sel:DWORD src1_sel:WORD_1
    v_cndmask_b32 v82, v83, v82, vcc
    v_cndmask_b32 v84, v85, v84, s[96:97]
    v_cndmask_b32 v86, v87, v86, s[100:101]
    v_add_u32_sdwa v82, v82, v177 dst_sel:WORD_0 dst_unused:UNUSED_PAD src0_sel:DWORD src1_sel:DWORD
    v_add_u32_sdwa v84, v84, v178 dst_sel:WORD_0 dst_unused:UNUSED_PAD src0_sel:DWORD src1_sel:DWORD
    v_add_u32_sdwa v86, v86, v179 dst_sel:WORD_0 dst_unused:UNUSED_PAD src0_sel:DWORD src1_sel:DWORD
    s_mov_b64 exec, s[52:53]
    ds_write2st64_b32 v82, v209, v236 offset0:164 offset1:212
    s_mov_b64 exec, s[54:55]
    ds_write2st64_b32 v84, v210, v237 offset0:164 offset1:212
    s_mov_b64 exec, s[56:57]
    ds_write2st64_b32 v86, v211, v238 offset0:164 offset1:212
    s_mov_b64 exec, -1
    s_cmp_eq_u64 s[58:59], 0
    s_cbranch_scc1 K_P2D
    v_cmp_lt_u32_sdwa vcc, v180, v88 src0_sel:DWORD src1_sel:WORD_1
    v_cmp_lt_u32_sdwa s[96:97], v181, v90 src0_sel:DWORD src1_sel:WORD_1
    v_cmp_lt_u32_sdwa s[100:101], v182, v92 src0_sel:DWORD src1_sel:WORD_1
    v_cndmask_b32 v88, v89, v88, vcc
    v_cndmask_b32 v90, v91, v90, s[96:97]
    v_cndmask_b32 v92, v93, v92, s[100:101]
    v_add_u32_sdwa v88, v88, v180 dst_sel:WORD_0 dst_unused:UNUSED_PAD src0_sel:DWORD src1_sel:DWORD
    v_add_u32_sdwa v90, v90, v181 dst_sel:WORD_0 dst_unused:UNUSED_PAD src0_sel:DWORD src1_sel:DWORD
    v_add_u32_sdwa v92, v92, v182 dst_sel:WORD_0 dst_unused:UNUSED_PAD src0_sel:DWORD src1_sel:DWORD
    s_mov_b64 exec, s[58:59]
    ds_write2st64_b32 v88, v212, v240 offset0:164 offset1:212
    s_mov_b64 exec, s[60:61]
    ds_write2st64_b32 v90, v213, v241 offset0:164 offset1:212
    s_mov_b64 exec, s[62:63]
    ds_write2st64_b32 v92, v214, v242 offset0:164 offset1:212
    s_mov_b64 exec, -1
    s_cmp_eq_u64 s[64:65], 0
    s_cbranch_scc1 K_P2D
    v_cmp_lt_u32_sdwa vcc, v183, v94 src0_sel:DWORD src1_sel:WORD_1
    v_cmp_lt_u32_sdwa s[96:97], v184, v96 src0_sel:DWORD src1_sel:WORD_1
    v_cmp_lt_u32_sdwa s[100:101], v185, v98 src0_sel:DWORD src1_sel:WORD_1
    v_cndmask_b32 v94, v95, v94, vcc
    v_cndmask_b32 v96, v97, v96, s[96:97]
    v_cndmask_b32 v98, v99, v98, s[100:101]
    v_add_u32_sdwa v94, v94, v183 dst_sel:WORD_0 dst_unused:UNUSED_PAD src0_sel:DWORD src1_sel:DWORD
    v_add_u32_sdwa v96, v96, v184 dst_sel:WORD_0 dst_unused:UNUSED_PAD src0_sel:DWORD src1_sel:DWORD
    v_add_u32_sdwa v98, v98, v185 dst_sel:WORD_0 dst_unused:UNUSED_PAD src0_sel:DWORD src1_sel:DWORD
    s_mov_b64 exec, s[64:65]
    ds_write2st64_b32 v94, v215, v244 offset0:164 offset1:212
    s_mov_b64 exec, s[66:67]
    ds_write2st64_b32 v96, v216, v245 offset0:164 offset1:212
    s_mov_b64 exec, s[68:69]
    ds_write2st64_b32 v98, v217, v246 offset0:164 offset1:212
    s_mov_b64 exec, -1
K_P2D:
    s_waitcnt lgkmcnt(0)
    s_barrier
    ds_read_b128 v[36:39], v3 offset:0
    ds_read_b32 v7, v4 offset:0
    ds_read2_b32 v[44:45], v5 offset0:0 offset1:4
    ds_read2_b32 v[46:47], v5 offset0:8 offset1:12
    v_add_u32 v5, 1024, v5
    s_waitcnt lgkmcnt(2)
    v_add_u32 v7, v7, v1
    v_mad_u32_u16 v36, v36, s26, v28
    v_mad_u32_u16 v37, v37, s26, v29
    v_mad_u32_u16 v38, v38, s26, v30
    v_mad_u32_u16 v39, v39, s26, v31
    buffer_load_dwordx4 v[216:219], v7, s[8:11], 0 offen
    s_add_u32 m0, s19, 0
    s_nop 0
    buffer_load_dwordx4 v36, s[4:7], 0 offen  lds
    s_add_u32 m0, s19, 1024
    s_nop 0
    buffer_load_dwordx4 v37, s[4:7], 0 offen  lds
    s_add_u32 m0, s19, 2048
    s_nop 0
    buffer_load_dwordx4 v38, s[4:7], 0 offen  lds
    s_add_u32 m0, s19, 3072
    s_nop 0
    buffer_load_dwordx4 v39, s[4:7], 0 offen  lds
    ds_read_b128 v[36:39], v3 offset:1024
    ds_read_b32 v7, v4 offset:1024
    s_and_b32 s21, s21, 0xffff
    s_add_u32 s21, s21, s29
    s_add_u32 s21, s21, 127
    s_lshr_b32 s21, s21, 7
    s_sub_u32 s20, 7, s18
    s_add_u32 s22, s22, s29
    s_add_u32 s22, s22, 127
    s_lshr_b32 s22, s22, 7
    s_add_u32 s29, s22, s20
    s_mov_b32 s98, s22
    s_add_u32 s20, s21, s20
    s_mov_b32 s99, s21
    s_lshr_b32 s29, s29, 3
    s_lshr_b32 s20, s20, 3
    s_cmp_lg_u32 s30, 0
    s_cselect_b32 s29, -1, s29
    s_cmp_eq_u32 s20, 0
    s_cbranch_scc1 K_WEND
    ds_read_b64_tr_b16 v[64:65], v19 offset:0
    ds_read_b64_tr_b16 v[66:67], v19 offset:512
    ds_read_b64_tr_b16 v[68:69], v19 offset:2048
    ds_read_b64_tr_b16 v[70:71], v19 offset:2560
    ds_read_b64_tr_b16 v[72:73], v19 offset:4096
    ds_read_b64_tr_b16 v[74:75], v19 offset:4608
    ds_read_b64_tr_b16 v[76:77], v19 offset:6144
    ds_read_b64_tr_b16 v[78:79], v19 offset:6656
    ds_read_b64_tr_b16 v[80:81], v19 offset:8192
    ds_read_b64_tr_b16 v[82:83], v19 offset:8704
    ds_read_b64_tr_b16 v[104:105], v19 offset:10240
    ds_read_b64_tr_b16 v[106:107], v19 offset:10752
    ds_read_b64_tr_b16 v[108:109], v19 offset:12288
    ds_read_b64_tr_b16 v[110:111], v19 offset:12800
    ds_read_b64_tr_b16 v[112:113], v19 offset:14336
    ds_read_b64_tr_b16 v[114:115], v19 offset:14848
    ds_read_b64_tr_b16 v[116:117], v19 offset:16384
    ds_read_b64_tr_b16 v[118:119], v19 offset:16896
    ds_read_b64_tr_b16 v[84:85], v19 offset:64
    ds_read_b64_tr_b16 v[86:87], v19 offset:576
    ds_read_b64_tr_b16 v[88:89], v19 offset:2112
    ds_read_b64_tr_b16 v[90:91], v19 offset:2624
    ds_read_b64_tr_b16 v[92:93], v19 offset:4160
    ds_read_b64_tr_b16 v[94:95], v19 offset:4672
    ds_read_b64_tr_b16 v[96:97], v19 offset:6208
    ds_read_b64_tr_b16 v[98:99], v19 offset:6720
    ds_read_b64_tr_b16 v[100:101], v19 offset:8256
    ds_read_b64_tr_b16 v[102:103], v19 offset:8768
    ds_read_b64_tr_b16 v[120:121], v19 offset:10304
    ds_read_b64_tr_b16 v[122:123], v19 offset:10816
    ds_read_b64_tr_b16 v[124:125], v19 offset:12352
    ds_read_b64_tr_b16 v[126:127], v19 offset:12864
    ds_read_b64_tr_b16 v[128:129], v19 offset:14400
    ds_read_b64_tr_b16 v[130:131], v19 offset:14912
    ds_read_b64_tr_b16 v[132:133], v19 offset:16448
    ds_read_b64_tr_b16 v[134:135], v19 offset:16960
    s_waitcnt lgkmcnt(0)
    v_add_u32 v7, v7, v1
    v_mad_u32_u16 v36, v36, s26, v28
    v_mad_u32_u16 v37, v37, s26, v29
    v_mad_u32_u16 v38, v38, s26, v30
    v_mad_u32_u16 v39, v39, s26, v31
    v_add_u32_sdwa v40, v44, v6 dst_sel:DWORD dst_unused:UNUSED_PAD src0_sel:WORD_1 src1_sel:DWORD
    v_add_u32_sdwa v41, v45, v6 dst_sel:DWORD dst_unused:UNUSED_PAD src0_sel:WORD_1 src1_sel:DWORD
    v_add_u32_sdwa v42, v46, v6 dst_sel:DWORD dst_unused:UNUSED_PAD src0_sel:WORD_1 src1_sel:DWORD
    v_add_u32_sdwa v43, v47, v6 dst_sel:DWORD dst_unused:UNUSED_PAD src0_sel:WORD_1 src1_sel:DWORD
    ds_read_b64 v[48:49], v40 offset:1024
    ds_read_b64 v[50:51], v41 offset:1024
    ds_read_b64 v[52:53], v42 offset:1024
    ds_read_b64 v[54:55], v43 offset:1024
    s_waitcnt vmcnt(0)
    ds_read_b128 v[200:203], v32 offset:0
    ds_read_b128 v[204:207], v33 offset:0
    ds_read_b128 v[208:211], v34 offset:0
    ds_read_b128 v[212:215], v35 offset:0
    s_setprio 3
    v_mfma_f32_32x32x16_bf16 v[136:151], v[216:219], v[80:83], 0
    buffer_load_dwordx4 v[220:223], v7, s[8:11], 0 offen
    s_waitcnt lgkmcnt(3)
    s_add_u32 m0, s19, 4096
    v_mfma_f32_32x32x16_bf16 v[136:151], v[200:203], v[64:67], v[136:151]
    buffer_load_dwordx4 v36, s[4:7], 0 offen  lds
    s_waitcnt lgkmcnt(2)
    s_add_u32 m0, s19, 5120
    v_mfma_f32_32x32x16_bf16 v[136:151], v[204:207], v[68:71], v[136:151]
    buffer_load_dwordx4 v37, s[4:7], 0 offen  lds
    s_waitcnt lgkmcnt(1)
    s_add_u32 m0, s19, 6144
    v_mfma_f32_32x32x16_bf16 v[136:151], v[208:211], v[72:75], v[136:151]
    buffer_load_dwordx4 v38, s[4:7], 0 offen  lds
    s_waitcnt lgkmcnt(0)
    s_add_u32 m0, s19, 7168
    v_mfma_f32_32x32x16_bf16 v[136:151], v[212:215], v[76:79], v[136:151]
    buffer_load_dwordx4 v39, s[4:7], 0 offen  lds
    ds_read_b128 v[36:39], v3 offset:2048
    ds_read_b32 v7, v4 offset:2048
    v_mfma_f32_32x32x16_bf16 v[168:183], v[200:203], v[104:107], 0
    v_mfma_f32_32x32x16_bf16 v[168:183], v[204:207], v[108:111], v[168:183]
    v_mfma_f32_32x32x16_bf16 v[168:183], v[208:211], v[112:115], v[168:183]
    v_mfma_f32_32x32x16_bf16 v[168:183], v[212:215], v[116:119], v[168:183]
    s_waitcnt lgkmcnt(0)
    v_add_u32 v7, v7, v1
    v_mad_u32_u16 v36, v36, s26, v28
    v_mad_u32_u16 v37, v37, s26, v29
    v_mad_u32_u16 v38, v38, s26, v30
    v_mad_u32_u16 v39, v39, s26, v31
    s_nop 3
    s_cmp_eq_u32 s29, 0
    s_cbranch_scc1 K_PURE0
K_GEN0:
    s_cmp_lg_u32 s30, 0
    s_cbranch_scc1 K_FB1
K_FR1:
    v_mfma_f32_32x32x16_bf16 v[152:167], v[216:219], v[100:103], 0
    v_exp_f32 v136, v136
    v_exp_f32 v137, v137
    v_exp_f32 v138, v138
    v_mfma_f32_32x32x16_bf16 v[152:167], v[200:203], v[84:87], v[152:167]
    v_exp_f32 v139, v139
    v_exp_f32 v140, v140
    v_exp_f32 v141, v141
    v_mfma_f32_32x32x16_bf16 v[152:167], v[204:207], v[88:91], v[152:167]
    v_exp_f32 v142, v142
    v_exp_f32 v143, v143
    v_exp_f32 v144, v144
    v_mfma_f32_32x32x16_bf16 v[152:167], v[208:211], v[92:95], v[152:167]
    v_exp_f32 v145, v145
    v_exp_f32 v146, v146
    v_exp_f32 v147, v147
    v_mfma_f32_32x32x16_bf16 v[152:167], v[212:215], v[96:99], v[152:167]
    v_exp_f32 v148, v148
    v_exp_f32 v149, v149
    v_exp_f32 v150, v150
    v_exp_f32 v151, v151
    s_waitcnt lgkmcnt(0)
    v_pk_fma_f32 v[136:137], v[136:137], v[48:49], 1.0 op_sel:[0,0,0] op_sel_hi:[1,0,0]
    v_pk_fma_f32 v[138:139], v[138:139], v[48:49], 1.0 op_sel:[0,0,0] op_sel_hi:[1,0,0]
    v_pk_fma_f32 v[140:141], v[140:141], v[50:51], 1.0 op_sel:[0,0,0] op_sel_hi:[1,0,0]
    v_pk_fma_f32 v[142:143], v[142:143], v[50:51], 1.0 op_sel:[0,0,0] op_sel_hi:[1,0,0]
    v_pk_fma_f32 v[144:145], v[144:145], v[52:53], 1.0 op_sel:[0,0,0] op_sel_hi:[1,0,0]
    v_pk_fma_f32 v[146:147], v[146:147], v[52:53], 1.0 op_sel:[0,0,0] op_sel_hi:[1,0,0]
    v_pk_fma_f32 v[148:149], v[148:149], v[54:55], 1.0 op_sel:[0,0,0] op_sel_hi:[1,0,0]
    v_pk_fma_f32 v[150:151], v[150:151], v[54:55], 1.0 op_sel:[0,0,0] op_sel_hi:[1,0,0]
    v_mfma_f32_32x32x16_bf16 v[184:199], v[200:203], v[120:123], 0
    v_rcp_f32 v136, v136
    v_rcp_f32 v137, v137
    v_rcp_f32 v138, v138
    v_mfma_f32_32x32x16_bf16 v[184:199], v[204:207], v[124:127], v[184:199]
    v_rcp_f32 v139, v139
    v_rcp_f32 v140, v140
    v_rcp_f32 v141, v141
    v_mfma_f32_32x32x16_bf16 v[184:199], v[208:211], v[128:131], v[184:199]
    v_rcp_f32 v142, v142
    v_rcp_f32 v143, v143
    v_rcp_f32 v144, v144
    v_mfma_f32_32x32x16_bf16 v[184:199], v[212:215], v[132:135], v[184:199]
    s_waitcnt vmcnt(0)
    ds_read_b128 v[200:203], v32 offset:4096
    ds_read_b128 v[204:207], v33 offset:4096
    ds_read_b128 v[208:211], v34 offset:4096
    ds_read_b128 v[212:215], v35 offset:4096
    v_rcp_f32 v145, v145
    v_rcp_f32 v146, v146
    v_rcp_f32 v147, v147
    v_rcp_f32 v148, v148
    v_rcp_f32 v149, v149
    v_rcp_f32 v150, v150
    v_rcp_f32 v151, v151
    v_pk_mul_f32 v[56:57], v[136:137], v[168:169]
    v_pk_mul_f32 v[58:59], v[140:141], v[172:173]
    v_pk_mul_f32 v[60:61], v[144:145], v[176:177]
    v_pk_mul_f32 v[62:63], v[148:149], v[180:181]
    v_pk_fma_f32 v[56:57], v[138:139], v[170:171], v[56:57]
    v_pk_fma_f32 v[58:59], v[142:143], v[174:175], v[58:59]
    v_pk_fma_f32 v[60:61], v[146:147], v[178:179], v[60:61]
    v_pk_fma_f32 v[62:63], v[150:151], v[182:183], v[62:63]
    v_add_f32 v56, v56, v57
    v_add_f32 v58, v58, v59
    v_add_f32 v60, v60, v61
    v_add_f32 v62, v62, v63
    v_cvt_f64_f32 v[56:57], v56
    v_cvt_f64_f32 v[58:59], v58
    v_cvt_f64_f32 v[60:61], v60
    v_cvt_f64_f32 v[62:63], v62
    ds_add_f64 v40, v[56:57] offset:1536
    ds_add_f64 v41, v[58:59] offset:1536
    ds_add_f64 v42, v[60:61] offset:1536
    ds_add_f64 v43, v[62:63] offset:1536
    s_sub_u32 s20, s20, 1
    s_cmp_eq_u32 s20, 0
    s_cbranch_scc1 K_LASTG
    s_cmp_lg_u32 s30, 0
    s_cbranch_scc1 K_FB2
K_FR2:
    v_mfma_f32_32x32x16_bf16 v[136:151], v[220:223], v[80:83], 0
    buffer_load_dwordx4 v[216:219], v7, s[8:11], 0 offen
    v_exp_f32 v152, v152
    v_exp_f32 v153, v153
    v_exp_f32 v154, v154
    s_waitcnt lgkmcnt(7)
    s_add_u32 m0, s19, 0
    v_mfma_f32_32x32x16_bf16 v[136:151], v[200:203], v[64:67], v[136:151]
    buffer_load_dwordx4 v36, s[4:7], 0 offen  lds
    v_exp_f32 v155, v155
    v_exp_f32 v156, v156
    v_exp_f32 v157, v157
    s_waitcnt lgkmcnt(6)
    s_add_u32 m0, s19, 1024
    v_mfma_f32_32x32x16_bf16 v[136:151], v[204:207], v[68:71], v[136:151]
    buffer_load_dwordx4 v37, s[4:7], 0 offen  lds
    v_exp_f32 v158, v158
    v_exp_f32 v159, v159
    v_exp_f32 v160, v160
    s_waitcnt lgkmcnt(5)
    s_add_u32 m0, s19, 2048
    v_mfma_f32_32x32x16_bf16 v[136:151], v[208:211], v[72:75], v[136:151]
    buffer_load_dwordx4 v38, s[4:7], 0 offen  lds
    v_exp_f32 v161, v161
    v_exp_f32 v162, v162
    v_exp_f32 v163, v163
    s_waitcnt lgkmcnt(4)
    s_add_u32 m0, s19, 3072
    v_mfma_f32_32x32x16_bf16 v[136:151], v[212:215], v[76:79], v[136:151]
    buffer_load_dwordx4 v39, s[4:7], 0 offen  lds
    ds_read_b128 v[36:39], v3 offset:3072
    ds_read_b32 v7, v4 offset:3072
    ds_read2_b32 v[44:45], v5 offset0:0 offset1:4
    ds_read2_b32 v[46:47], v5 offset0:8 offset1:12
    v_add_u32 v5, 1024, v5
    v_exp_f32 v164, v164
    v_exp_f32 v165, v165
    v_exp_f32 v166, v166
    v_exp_f32 v167, v167
    v_pk_fma_f32 v[152:153], v[152:153], v[48:49], 1.0 op_sel:[0,1,0] op_sel_hi:[1,1,0]
    v_pk_fma_f32 v[154:155], v[154:155], v[48:49], 1.0 op_sel:[0,1,0] op_sel_hi:[1,1,0]
    v_pk_fma_f32 v[156:157], v[156:157], v[50:51], 1.0 op_sel:[0,1,0] op_sel_hi:[1,1,0]
    v_pk_fma_f32 v[158:159], v[158:159], v[50:51], 1.0 op_sel:[0,1,0] op_sel_hi:[1,1,0]
    v_pk_fma_f32 v[160:161], v[160:161], v[52:53], 1.0 op_sel:[0,1,0] op_sel_hi:[1,1,0]
    v_pk_fma_f32 v[162:163], v[162:163], v[52:53], 1.0 op_sel:[0,1,0] op_sel_hi:[1,1,0]
    v_pk_fma_f32 v[164:165], v[164:165], v[54:55], 1.0 op_sel:[0,1,0] op_sel_hi:[1,1,0]
    v_pk_fma_f32 v[166:167], v[166:167], v[54:55], 1.0 op_sel:[0,1,0] op_sel_hi:[1,1,0]
    v_mfma_f32_32x32x16_bf16 v[168:183], v[200:203], v[104:107], 0
    v_rcp_f32 v152, v152
    v_rcp_f32 v153, v153
    v_rcp_f32 v154, v154
    v_mfma_f32_32x32x16_bf16 v[168:183], v[204:207], v[108:111], v[168:183]
    v_rcp_f32 v155, v155
    v_rcp_f32 v156, v156
    v_rcp_f32 v157, v157
    s_waitcnt lgkmcnt(0)
    v_add_u32 v7, v7, v1
    v_mad_u32_u16 v36, v36, s26, v28
    v_mad_u32_u16 v37, v37, s26, v29
    v_mad_u32_u16 v38, v38, s26, v30
    v_mad_u32_u16 v39, v39, s26, v31
    v_mfma_f32_32x32x16_bf16 v[168:183], v[208:211], v[112:115], v[168:183]
    v_rcp_f32 v158, v158
    v_rcp_f32 v159, v159
    v_rcp_f32 v160, v160
    v_mfma_f32_32x32x16_bf16 v[168:183], v[212:215], v[116:119], v[168:183]
    v_rcp_f32 v161, v161
    v_rcp_f32 v162, v162
    v_rcp_f32 v163, v163
    v_rcp_f32 v164, v164
    v_rcp_f32 v165, v165
    v_rcp_f32 v166, v166
    v_rcp_f32 v167, v167
    v_pk_mul_f32 v[56:57], v[152:153], v[184:185]
    v_pk_mul_f32 v[58:59], v[156:157], v[188:189]
    v_pk_mul_f32 v[60:61], v[160:161], v[192:193]
    v_pk_mul_f32 v[62:63], v[164:165], v[196:197]
    v_pk_fma_f32 v[56:57], v[154:155], v[186:187], v[56:57]
    v_pk_fma_f32 v[58:59], v[158:159], v[190:191], v[58:59]
    v_pk_fma_f32 v[60:61], v[162:163], v[194:195], v[60:61]
    v_pk_fma_f32 v[62:63], v[166:167], v[198:199], v[62:63]
    v_add_f32 v56, v56, v57
    v_add_f32 v58, v58, v59
    v_add_f32 v60, v60, v61
    v_add_f32 v62, v62, v63
    v_cvt_f64_f32 v[56:57], v56
    v_cvt_f64_f32 v[58:59], v58
    v_cvt_f64_f32 v[60:61], v60
    v_cvt_f64_f32 v[62:63], v62
    ds_add_f64 v40, v[56:57] offset:1792
    ds_add_f64 v41, v[58:59] offset:1792
    ds_add_f64 v42, v[60:61] offset:1792
    ds_add_f64 v43, v[62:63] offset:1792
    v_add_u32_sdwa v40, v44, v6 dst_sel:DWORD dst_unused:UNUSED_PAD src0_sel:WORD_1 src1_sel:DWORD
    v_add_u32_sdwa v41, v45, v6 dst_sel:DWORD dst_unused:UNUSED_PAD src0_sel:WORD_1 src1_sel:DWORD
    v_add_u32_sdwa v42, v46, v6 dst_sel:DWORD dst_unused:UNUSED_PAD src0_sel:WORD_1 src1_sel:DWORD
    v_add_u32_sdwa v43, v47, v6 dst_sel:DWORD dst_unused:UNUSED_PAD src0_sel:WORD_1 src1_sel:DWORD
    ds_read_b64 v[48:49], v40 offset:1024
    ds_read_b64 v[50:51], v41 offset:1024
    ds_read_b64 v[52:53], v42 offset:1024
    ds_read_b64 v[54:55], v43 offset:1024
    s_sub_u32 s29, s29, 1
    s_cmp_eq_u32 s29, 0
    s_cbranch_scc1 K_PURE1
    s_cmp_lg_u32 s30, 0
    s_cbranch_scc1 K_FB3
K_FR3:
    v_mfma_f32_32x32x16_bf16 v[152:167], v[220:223], v[100:103], 0
    v_exp_f32 v136, v136
    v_exp_f32 v137, v137
    v_exp_f32 v138, v138
    v_mfma_f32_32x32x16_bf16 v[152:167], v[200:203], v[84:87], v[152:167]
    v_exp_f32 v139, v139
    v_exp_f32 v140, v140
    v_exp_f32 v141, v141
    v_mfma_f32_32x32x16_bf16 v[152:167], v[204:207], v[88:91], v[152:167]
    v_exp_f32 v142, v142
    v_exp_f32 v143, v143
    v_exp_f32 v144, v144
    v_mfma_f32_32x32x16_bf16 v[152:167], v[208:211], v[92:95], v[152:167]
    v_exp_f32 v145, v145
    v_exp_f32 v146, v146
    v_exp_f32 v147, v147
    v_mfma_f32_32x32x16_bf16 v[152:167], v[212:215], v[96:99], v[152:167]
    v_exp_f32 v148, v148
    v_exp_f32 v149, v149
    v_exp_f32 v150, v150
    v_exp_f32 v151, v151
    s_waitcnt lgkmcnt(0)
    v_pk_fma_f32 v[136:137], v[136:137], v[48:49], 1.0 op_sel:[0,0,0] op_sel_hi:[1,0,0]
    v_pk_fma_f32 v[138:139], v[138:139], v[48:49], 1.0 op_sel:[0,0,0] op_sel_hi:[1,0,0]
    v_pk_fma_f32 v[140:141], v[140:141], v[50:51], 1.0 op_sel:[0,0,0] op_sel_hi:[1,0,0]
    v_pk_fma_f32 v[142:143], v[142:143], v[50:51], 1.0 op_sel:[0,0,0] op_sel_hi:[1,0,0]
    v_pk_fma_f32 v[144:145], v[144:145], v[52:53], 1.0 op_sel:[0,0,0] op_sel_hi:[1,0,0]
    v_pk_fma_f32 v[146:147], v[146:147], v[52:53], 1.0 op_sel:[0,0,0] op_sel_hi:[1,0,0]
    v_pk_fma_f32 v[148:149], v[148:149], v[54:55], 1.0 op_sel:[0,0,0] op_sel_hi:[1,0,0]
    v_pk_fma_f32 v[150:151], v[150:151], v[54:55], 1.0 op_sel:[0,0,0] op_sel_hi:[1,0,0]
    v_mfma_f32_32x32x16_bf16 v[184:199], v[200:203], v[120:123], 0
    v_rcp_f32 v136, v136
    v_rcp_f32 v137, v137
    v_rcp_f32 v138, v138
    v_mfma_f32_32x32x16_bf16 v[184:199], v[204:207], v[124:127], v[184:199]
    v_rcp_f32 v139, v139
    v_rcp_f32 v140, v140
    v_rcp_f32 v141, v141
    v_mfma_f32_32x32x16_bf16 v[184:199], v[208:211], v[128:131], v[184:199]
    v_rcp_f32 v142, v142
    v_rcp_f32 v143, v143
    v_rcp_f32 v144, v144
    v_mfma_f32_32x32x16_bf16 v[184:199], v[212:215], v[132:135], v[184:199]
    s_waitcnt vmcnt(0)
    ds_read_b128 v[200:203], v32 offset:0
    ds_read_b128 v[204:207], v33 offset:0
    ds_read_b128 v[208:211], v34 offset:0
    ds_read_b128 v[212:215], v35 offset:0
    v_rcp_f32 v145, v145
    v_rcp_f32 v146, v146
    v_rcp_f32 v147, v147
    v_rcp_f32 v148, v148
    v_rcp_f32 v149, v149
    v_rcp_f32 v150, v150
    v_rcp_f32 v151, v151
    v_pk_mul_f32 v[56:57], v[136:137], v[168:169]
    v_pk_mul_f32 v[58:59], v[140:141], v[172:173]
    v_pk_mul_f32 v[60:61], v[144:145], v[176:177]
    v_pk_mul_f32 v[62:63], v[148:149], v[180:181]
    v_pk_fma_f32 v[56:57], v[138:139], v[170:171], v[56:57]
    v_pk_fma_f32 v[58:59], v[142:143], v[174:175], v[58:59]
    v_pk_fma_f32 v[60:61], v[146:147], v[178:179], v[60:61]
    v_pk_fma_f32 v[62:63], v[150:151], v[182:183], v[62:63]
    v_add_f32 v56, v56, v57
    v_add_f32 v58, v58, v59
    v_add_f32 v60, v60, v61
    v_add_f32 v62, v62, v63
    v_cvt_f64_f32 v[56:57], v56
    v_cvt_f64_f32 v[58:59], v58
    v_cvt_f64_f32 v[60:61], v60
    v_cvt_f64_f32 v[62:63], v62
    ds_add_f64 v40, v[56:57] offset:1536
    ds_add_f64 v41, v[58:59] offset:1536
    ds_add_f64 v42, v[60:61] offset:1536
    ds_add_f64 v43, v[62:63] offset:1536
    s_sub_u32 s20, s20, 1
    s_cmp_eq_u32 s20, 0
    s_cbranch_scc1 K_LASTG
    s_cmp_lg_u32 s30, 0
    s_cbranch_scc1 K_FB4
K_FR4:
    v_mfma_f32_32x32x16_bf16 v[136:151], v[216:219], v[80:83], 0
    buffer_load_dwordx4 v[220:223], v7, s[8:11], 0 offen
    v_exp_f32 v152, v152
    v_exp_f32 v153, v153
    v_exp_f32 v154, v154
    s_waitcnt lgkmcnt(7)
    s_add_u32 m0, s19, 4096
    v_mfma_f32_32x32x16_bf16 v[136:151], v[200:203], v[64:67], v[136:151]
    buffer_load_dwordx4 v36, s[4:7], 0 offen  lds
    v_exp_f32 v155, v155
    v_exp_f32 v156, v156
    v_exp_f32 v157, v157
    s_waitcnt lgkmcnt(6)
    s_add_u32 m0, s19, 5120
    v_mfma_f32_32x32x16_bf16 v[136:151], v[204:207], v[68:71], v[136:151]
    buffer_load_dwordx4 v37, s[4:7], 0 offen  lds
    v_exp_f32 v158, v158
    v_exp_f32 v159, v159
    v_exp_f32 v160, v160
    s_waitcnt lgkmcnt(5)
    s_add_u32 m0, s19, 6144
    v_mfma_f32_32x32x16_bf16 v[136:151], v[208:211], v[72:75], v[136:151]
    buffer_load_dwordx4 v38, s[4:7], 0 offen  lds
    v_exp_f32 v161, v161
    v_exp_f32 v162, v162
    v_exp_f32 v163, v163
    s_waitcnt lgkmcnt(4)
    s_add_u32 m0, s19, 7168
    v_mfma_f32_32x32x16_bf16 v[136:151], v[212:215], v[76:79], v[136:151]
    buffer_load_dwordx4 v39, s[4:7], 0 offen  lds
    ds_read_b128 v[36:39], v3 offset:4096
    ds_read_b32 v7, v4 offset:4096
    ds_read2_b32 v[44:45], v5 offset0:0 offset1:4
    ds_read2_b32 v[46:47], v5 offset0:8 offset1:12
    v_add_u32 v5, 1024, v5
    v_exp_f32 v164, v164
    v_exp_f32 v165, v165
    v_exp_f32 v166, v166
    v_exp_f32 v167, v167
    v_pk_fma_f32 v[152:153], v[152:153], v[48:49], 1.0 op_sel:[0,1,0] op_sel_hi:[1,1,0]
    v_pk_fma_f32 v[154:155], v[154:155], v[48:49], 1.0 op_sel:[0,1,0] op_sel_hi:[1,1,0]
    v_pk_fma_f32 v[156:157], v[156:157], v[50:51], 1.0 op_sel:[0,1,0] op_sel_hi:[1,1,0]
    v_pk_fma_f32 v[158:159], v[158:159], v[50:51], 1.0 op_sel:[0,1,0] op_sel_hi:[1,1,0]
    v_pk_fma_f32 v[160:161], v[160:161], v[52:53], 1.0 op_sel:[0,1,0] op_sel_hi:[1,1,0]
    v_pk_fma_f32 v[162:163], v[162:163], v[52:53], 1.0 op_sel:[0,1,0] op_sel_hi:[1,1,0]
    v_pk_fma_f32 v[164:165], v[164:165], v[54:55], 1.0 op_sel:[0,1,0] op_sel_hi:[1,1,0]
    v_pk_fma_f32 v[166:167], v[166:167], v[54:55], 1.0 op_sel:[0,1,0] op_sel_hi:[1,1,0]
    v_mfma_f32_32x32x16_bf16 v[168:183], v[200:203], v[104:107], 0
    v_rcp_f32 v152, v152
    v_rcp_f32 v153, v153
    v_rcp_f32 v154, v154
    v_mfma_f32_32x32x16_bf16 v[168:183], v[204:207], v[108:111], v[168:183]
    v_rcp_f32 v155, v155
    v_rcp_f32 v156, v156
    v_rcp_f32 v157, v157
    s_waitcnt lgkmcnt(0)
    v_add_u32 v7, v7, v1
    v_mad_u32_u16 v36, v36, s26, v28
    v_mad_u32_u16 v37, v37, s26, v29
    v_mad_u32_u16 v38, v38, s26, v30
    v_mad_u32_u16 v39, v39, s26, v31
    v_mfma_f32_32x32x16_bf16 v[168:183], v[208:211], v[112:115], v[168:183]
    v_rcp_f32 v158, v158
    v_rcp_f32 v159, v159
    v_rcp_f32 v160, v160
    v_mfma_f32_32x32x16_bf16 v[168:183], v[212:215], v[116:119], v[168:183]
    v_rcp_f32 v161, v161
    v_rcp_f32 v162, v162
    v_rcp_f32 v163, v163
    v_rcp_f32 v164, v164
    v_rcp_f32 v165, v165
    v_rcp_f32 v166, v166
    v_rcp_f32 v167, v167
    v_pk_mul_f32 v[56:57], v[152:153], v[184:185]
    v_pk_mul_f32 v[58:59], v[156:157], v[188:189]
    v_pk_mul_f32 v[60:61], v[160:161], v[192:193]
    v_pk_mul_f32 v[62:63], v[164:165], v[196:197]
    v_pk_fma_f32 v[56:57], v[154:155], v[186:187], v[56:57]
    v_pk_fma_f32 v[58:59], v[158:159], v[190:191], v[58:59]
    v_pk_fma_f32 v[60:61], v[162:163], v[194:195], v[60:61]
    v_pk_fma_f32 v[62:63], v[166:167], v[198:199], v[62:63]
    v_add_f32 v56, v56, v57
    v_add_f32 v58, v58, v59
    v_add_f32 v60, v60, v61
    v_add_f32 v62, v62, v63
    v_cvt_f64_f32 v[56:57], v56
    v_cvt_f64_f32 v[58:59], v58
    v_cvt_f64_f32 v[60:61], v60
    v_cvt_f64_f32 v[62:63], v62
    ds_add_f64 v40, v[56:57] offset:1792
    ds_add_f64 v41, v[58:59] offset:1792
    ds_add_f64 v42, v[60:61] offset:1792
    ds_add_f64 v43, v[62:63] offset:1792
    v_add_u32_sdwa v40, v44, v6 dst_sel:DWORD dst_unused:UNUSED_PAD src0_sel:WORD_1 src1_sel:DWORD
    v_add_u32_sdwa v41, v45, v6 dst_sel:DWORD dst_unused:UNUSED_PAD src0_sel:WORD_1 src1_sel:DWORD
    v_add_u32_sdwa v42, v46, v6 dst_sel:DWORD dst_unused:UNUSED_PAD src0_sel:WORD_1 src1_sel:DWORD
    v_add_u32_sdwa v43, v47, v6 dst_sel:DWORD dst_unused:UNUSED_PAD src0_sel:WORD_1 src1_sel:DWORD
    ds_read_b64 v[48:49], v40 offset:1024
    ds_read_b64 v[50:51], v41 offset:1024
    ds_read_b64 v[52:53], v42 offset:1024
    ds_read_b64 v[54:55], v43 offset:1024
    v_add_u32 v3, 2048, v3
    v_add_u32 v4, 2048, v4
    s_sub_u32 s29, s29, 1
    s_cmp_eq_u32 s29, 0
    s_cbranch_scc0 K_GEN0
K_PURE0:
    s_cmp_le_u32 s20, 4
    s_cbranch_scc1 K_PB5
K_PR5:
    v_mfma_f32_32x32x16_bf16 v[152:167], v[216:219], v[100:103], 0
    v_exp_f32 v136, v136
    v_exp_f32 v137, v137
    v_exp_f32 v138, v138
    v_mfma_f32_32x32x16_bf16 v[152:167], v[200:203], v[84:87], v[152:167]
    v_exp_f32 v139, v139
    v_exp_f32 v140, v140
    v_exp_f32 v141, v141
    v_mfma_f32_32x32x16_bf16 v[152:167], v[204:207], v[88:91], v[152:167]
    v_exp_f32 v142, v142
    v_exp_f32 v143, v143
    v_exp_f32 v144, v144
    v_mfma_f32_32x32x16_bf16 v[152:167], v[208:211], v[92:95], v[152:167]
    v_exp_f32 v145, v145
    v_exp_f32 v146, v146
    v_exp_f32 v147, v147
    v_mfma_f32_32x32x16_bf16 v[152:167], v[212:215], v[96:99], v[152:167]
    v_exp_f32 v148, v148
    v_exp_f32 v149, v149
    v_exp_f32 v150, v150
    v_exp_f32 v151, v151
    s_waitcnt lgkmcnt(0)
    v_pk_fma_f32 v[136:137], v[136:137], v[48:49], 1.0 op_sel:[0,0,0] op_sel_hi:[1,0,0]
    v_pk_fma_f32 v[138:139], v[138:139], v[48:49], 1.0 op_sel:[0,0,0] op_sel_hi:[1,0,0]
    v_pk_fma_f32 v[140:141], v[140:141], v[48:49], 1.0 op_sel:[0,0,0] op_sel_hi:[1,0,0]
    v_pk_fma_f32 v[142:143], v[142:143], v[48:49], 1.0 op_sel:[0,0,0] op_sel_hi:[1,0,0]
    v_pk_fma_f32 v[144:145], v[144:145], v[48:49], 1.0 op_sel:[0,0,0] op_sel_hi:[1,0,0]
    v_pk_fma_f32 v[146:147], v[146:147], v[48:49], 1.0 op_sel:[0,0,0] op_sel_hi:[1,0,0]
    v_pk_fma_f32 v[148:149], v[148:149], v[48:49], 1.0 op_sel:[0,0,0] op_sel_hi:[1,0,0]
    v_pk_fma_f32 v[150:151], v[150:151], v[48:49], 1.0 op_sel:[0,0,0] op_sel_hi:[1,0,0]
    v_mfma_f32_32x32x16_bf16 v[184:199], v[200:203], v[120:123], 0
    v_rcp_f32 v136, v136
    v_rcp_f32 v137, v137
    v_rcp_f32 v138, v138
    v_mfma_f32_32x32x16_bf16 v[184:199], v[204:207], v[124:127], v[184:199]
    v_rcp_f32 v139, v139
    v_rcp_f32 v140, v140
    v_rcp_f32 v141, v141
    v_mfma_f32_32x32x16_bf16 v[184:199], v[208:211], v[128:131], v[184:199]
    v_rcp_f32 v142, v142
    v_rcp_f32 v143, v143
    v_rcp_f32 v144, v144
    v_mfma_f32_32x32x16_bf16 v[184:199], v[212:215], v[132:135], v[184:199]
    s_waitcnt vmcnt(0)
    ds_read_b128 v[200:203], v32 offset:4096
    ds_read_b128 v[204:207], v33 offset:4096
    ds_read_b128 v[208:211], v34 offset:4096
    ds_read_b128 v[212:215], v35 offset:4096
    v_rcp_f32 v145, v145
    v_rcp_f32 v146, v146
    v_rcp_f32 v147, v147
    v_rcp_f32 v148, v148
    v_rcp_f32 v149, v149
    v_rcp_f32 v150, v150
    v_rcp_f32 v151, v151
    v_pk_mul_f32 v[56:57], v[136:137], v[168:169]
    v_pk_fma_f32 v[56:57], v[138:139], v[170:171], v[56:57]
    v_pk_fma_f32 v[56:57], v[140:141], v[172:173], v[56:57]
    v_pk_fma_f32 v[56:57], v[142:143], v[174:175], v[56:57]
    v_pk_fma_f32 v[56:57], v[144:145], v[176:177], v[56:57]
    v_pk_fma_f32 v[56:57], v[146:147], v[178:179], v[56:57]
    v_pk_fma_f32 v[56:57], v[148:149], v[180:181], v[56:57]
    v_pk_fma_f32 v[56:57], v[150:151], v[182:183], v[56:57]
    v_add_f32 v56, v56, v57
    v_cvt_f64_f32 v[56:57], v56
    ds_add_f64 v40, v[56:57] offset:1536
    s_sub_u32 s20, s20, 1
    s_cmp_eq_u32 s20, 0
    s_cbranch_scc1 K_LASTP
    v_mfma_f32_32x32x16_bf16 v[136:151], v[220:223], v[80:83], 0
    buffer_load_dwordx4 v[216:219], v7, s[8:11], 0 offen
    v_exp_f32 v152, v152
    v_exp_f32 v153, v153
    v_exp_f32 v154, v154
    s_waitcnt lgkmcnt(4)
    s_add_u32 m0, s19, 0
    v_mfma_f32_32x32x16_bf16 v[136:151], v[200:203], v[64:67], v[136:151]
    buffer_load_dwordx4 v36, s[4:7], 0 offen  lds
    v_exp_f32 v155, v155
    v_exp_f32 v156, v156
    v_exp_f32 v157, v157
    s_waitcnt lgkmcnt(3)
    s_add_u32 m0, s19, 1024
    v_mfma_f32_32x32x16_bf16 v[136:151], v[204:207], v[68:71], v[136:151]
    buffer_load_dwordx4 v37, s[4:7], 0 offen  lds
    v_exp_f32 v158, v158
    v_exp_f32 v159, v159
    v_exp_f32 v160, v160
    s_waitcnt lgkmcnt(2)
    s_add_u32 m0, s19, 2048
    v_mfma_f32_32x32x16_bf16 v[136:151], v[208:211], v[72:75], v[136:151]
    buffer_load_dwordx4 v38, s[4:7], 0 offen  lds
    v_exp_f32 v161, v161
    v_exp_f32 v162, v162
    v_exp_f32 v163, v163
    s_waitcnt lgkmcnt(1)
    s_add_u32 m0, s19, 3072
    v_mfma_f32_32x32x16_bf16 v[136:151], v[212:215], v[76:79], v[136:151]
    buffer_load_dwordx4 v39, s[4:7], 0 offen  lds
    ds_read_b128 v[36:39], v3 offset:3072
    ds_read_b32 v7, v4 offset:3072
    ds_read_b32 v44, v5
    v_add_u32 v5, 1024, v5
    v_exp_f32 v164, v164
    v_exp_f32 v165, v165
    v_exp_f32 v166, v166
    v_exp_f32 v167, v167
    v_pk_fma_f32 v[152:153], v[152:153], v[48:49], 1.0 op_sel:[0,1,0] op_sel_hi:[1,1,0]
    v_pk_fma_f32 v[154:155], v[154:155], v[48:49], 1.0 op_sel:[0,1,0] op_sel_hi:[1,1,0]
    v_pk_fma_f32 v[156:157], v[156:157], v[48:49], 1.0 op_sel:[0,1,0] op_sel_hi:[1,1,0]
    v_pk_fma_f32 v[158:159], v[158:159], v[48:49], 1.0 op_sel:[0,1,0] op_sel_hi:[1,1,0]
    v_pk_fma_f32 v[160:161], v[160:161], v[48:49], 1.0 op_sel:[0,1,0] op_sel_hi:[1,1,0]
    v_pk_fma_f32 v[162:163], v[162:163], v[48:49], 1.0 op_sel:[0,1,0] op_sel_hi:[1,1,0]
    v_pk_fma_f32 v[164:165], v[164:165], v[48:49], 1.0 op_sel:[0,1,0] op_sel_hi:[1,1,0]
    v_pk_fma_f32 v[166:167], v[166:167], v[48:49], 1.0 op_sel:[0,1,0] op_sel_hi:[1,1,0]
    v_mfma_f32_32x32x16_bf16 v[168:183], v[200:203], v[104:107], 0
    v_rcp_f32 v152, v152
    v_rcp_f32 v153, v153
    v_rcp_f32 v154, v154
    v_mfma_f32_32x32x16_bf16 v[168:183], v[204:207], v[108:111], v[168:183]
    v_rcp_f32 v155, v155
    v_rcp_f32 v156, v156
    v_rcp_f32 v157, v157
    s_waitcnt lgkmcnt(0)
    v_add_u32 v7, v7, v1
    v_mad_u32_u16 v36, v36, s26, v28
    v_mad_u32_u16 v37, v37, s26, v29
    v_mad_u32_u16 v38, v38, s26, v30
    v_mad_u32_u16 v39, v39, s26, v31
    v_mfma_f32_32x32x16_bf16 v[168:183], v[208:211], v[112:115], v[168:183]
    v_rcp_f32 v158, v158
    v_rcp_f32 v159, v159
    v_rcp_f32 v160, v160
    v_mfma_f32_32x32x16_bf16 v[168:183], v[212:215], v[116:119], v[168:183]
    v_rcp_f32 v161, v161
    v_rcp_f32 v162, v162
    v_rcp_f32 v163, v163
    v_rcp_f32 v164, v164
    v_rcp_f32 v165, v165
    v_rcp_f32 v166, v166
    v_rcp_f32 v167, v167
    v_pk_mul_f32 v[56:57], v[152:153], v[184:185]
    v_pk_fma_f32 v[56:57], v[154:155], v[186:187], v[56:57]
    v_pk_fma_f32 v[56:57], v[156:157], v[188:189], v[56:57]
    v_pk_fma_f32 v[56:57], v[158:159], v[190:191], v[56:57]
    v_pk_fma_f32 v[56:57], v[160:161], v[192:193], v[56:57]
    v_pk_fma_f32 v[56:57], v[162:163], v[194:195], v[56:57]
    v_pk_fma_f32 v[56:57], v[164:165], v[196:197], v[56:57]
    v_pk_fma_f32 v[56:57], v[166:167], v[198:199], v[56:57]
    v_add_f32 v56, v56, v57
    v_cvt_f64_f32 v[56:57], v56
    ds_add_f64 v40, v[56:57] offset:1792
    v_add_u32_sdwa v40, v44, v6 dst_sel:DWORD dst_unused:UNUSED_PAD src0_sel:WORD_1 src1_sel:DWORD
    ds_read_b64 v[48:49], v40 offset:1024
K_PURE1:
    s_cmp_le_u32 s20, 4
    s_cbranch_scc1 K_PB6
K_PR6:
    v_mfma_f32_32x32x16_bf16 v[152:167], v[220:223], v[100:103], 0
    v_exp_f32 v136, v136
    v_exp_f32 v137, v137
    v_exp_f32 v138, v138
    v_mfma_f32_32x32x16_bf16 v[152:167], v[200:203], v[84:87], v[152:167]
    v_exp_f32 v139, v139
    v_exp_f32 v140, v140
    v_exp_f32 v141, v141
    v_mfma_f32_32x32x16_bf16 v[152:167], v[204:207], v[88:91], v[152:167]
    v_exp_f32 v142, v142
    v_exp_f32 v143, v143
    v_exp_f32 v144, v144
    v_mfma_f32_32x32x16_bf16 v[152:167], v[208:211], v[92:95], v[152:167]
    v_exp_f32 v145, v145
    v_exp_f32 v146, v146
    v_exp_f32 v147, v147
    v_mfma_f32_32x32x16_bf16 v[152:167], v[212:215], v[96:99], v[152:167]
    v_exp_f32 v148, v148
    v_exp_f32 v149, v149
    v_exp_f32 v150, v150
    v_exp_f32 v151, v151
    s_waitcnt lgkmcnt(0)
    v_pk_fma_f32 v[136:137], v[136:137], v[48:49], 1.0 op_sel:[0,0,0] op_sel_hi:[1,0,0]
    v_pk_fma_f32 v[138:139], v[138:139], v[48:49], 1.0 op_sel:[0,0,0] op_sel_hi:[1,0,0]
    v_pk_fma_f32 v[140:141], v[140:141], v[48:49], 1.0 op_sel:[0,0,0] op_sel_hi:[1,0,0]
    v_pk_fma_f32 v[142:143], v[142:143], v[48:49], 1.0 op_sel:[0,0,0] op_sel_hi:[1,0,0]
    v_pk_fma_f32 v[144:145], v[144:145], v[48:49], 1.0 op_sel:[0,0,0] op_sel_hi:[1,0,0]
    v_pk_fma_f32 v[146:147], v[146:147], v[48:49], 1.0 op_sel:[0,0,0] op_sel_hi:[1,0,0]
    v_pk_fma_f32 v[148:149], v[148:149], v[48:49], 1.0 op_sel:[0,0,0] op_sel_hi:[1,0,0]
    v_pk_fma_f32 v[150:151], v[150:151], v[48:49], 1.0 op_sel:[0,0,0] op_sel_hi:[1,0,0]
    v_mfma_f32_32x32x16_bf16 v[184:199], v[200:203], v[120:123], 0
    v_rcp_f32 v136, v136
    v_rcp_f32 v137, v137
    v_rcp_f32 v138, v138
    v_mfma_f32_32x32x16_bf16 v[184:199], v[204:207], v[124:127], v[184:199]
    v_rcp_f32 v139, v139
    v_rcp_f32 v140, v140
    v_rcp_f32 v141, v141
    v_mfma_f32_32x32x16_bf16 v[184:199], v[208:211], v[128:131], v[184:199]
    v_rcp_f32 v142, v142
    v_rcp_f32 v143, v143
    v_rcp_f32 v144, v144
    v_mfma_f32_32x32x16_bf16 v[184:199], v[212:215], v[132:135], v[184:199]
    s_waitcnt vmcnt(0)
    ds_read_b128 v[200:203], v32 offset:0
    ds_read_b128 v[204:207], v33 offset:0
    ds_read_b128 v[208:211], v34 offset:0
    ds_read_b128 v[212:215], v35 offset:0
    v_rcp_f32 v145, v145
    v_rcp_f32 v146, v146
    v_rcp_f32 v147, v147
    v_rcp_f32 v148, v148
    v_rcp_f32 v149, v149
    v_rcp_f32 v150, v150
    v_rcp_f32 v151, v151
    v_pk_mul_f32 v[56:57], v[136:137], v[168:169]
    v_pk_fma_f32 v[56:57], v[138:139], v[170:171], v[56:57]
    v_pk_fma_f32 v[56:57], v[140:141], v[172:173], v[56:57]
    v_pk_fma_f32 v[56:57], v[142:143], v[174:175], v[56:57]
    v_pk_fma_f32 v[56:57], v[144:145], v[176:177], v[56:57]
    v_pk_fma_f32 v[56:57], v[146:147], v[178:179], v[56:57]
    v_pk_fma_f32 v[56:57], v[148:149], v[180:181], v[56:57]
    v_pk_fma_f32 v[56:57], v[150:151], v[182:183], v[56:57]
    v_add_f32 v56, v56, v57
    v_cvt_f64_f32 v[56:57], v56
    ds_add_f64 v40, v[56:57] offset:1536
    s_sub_u32 s20, s20, 1
    s_cmp_eq_u32 s20, 0
    s_cbranch_scc1 K_LASTP
    v_mfma_f32_32x32x16_bf16 v[136:151], v[216:219], v[80:83], 0
    buffer_load_dwordx4 v[220:223], v7, s[8:11], 0 offen
    v_exp_f32 v152, v152
    v_exp_f32 v153, v153
    v_exp_f32 v154, v154
    s_waitcnt lgkmcnt(4)
    s_add_u32 m0, s19, 4096
    v_mfma_f32_32x32x16_bf16 v[136:151], v[200:203], v[64:67], v[136:151]
    buffer_load_dwordx4 v36, s[4:7], 0 offen  lds
    v_exp_f32 v155, v155
    v_exp_f32 v156, v156
    v_exp_f32 v157, v157
    s_waitcnt lgkmcnt(3)
    s_add_u32 m0, s19, 5120
    v_mfma_f32_32x32x16_bf16 v[136:151], v[204:207], v[68:71], v[136:151]
    buffer_load_dwordx4 v37, s[4:7], 0 offen  lds
    v_exp_f32 v158, v158
    v_exp_f32 v159, v159
    v_exp_f32 v160, v160
    s_waitcnt lgkmcnt(2)
    s_add_u32 m0, s19, 6144
    v_mfma_f32_32x32x16_bf16 v[136:151], v[208:211], v[72:75], v[136:151]
    buffer_load_dwordx4 v38, s[4:7], 0 offen  lds
    v_exp_f32 v161, v161
    v_exp_f32 v162, v162
    v_exp_f32 v163, v163
    s_waitcnt lgkmcnt(1)
    s_add_u32 m0, s19, 7168
    v_mfma_f32_32x32x16_bf16 v[136:151], v[212:215], v[76:79], v[136:151]
    buffer_load_dwordx4 v39, s[4:7], 0 offen  lds
    ds_read_b128 v[36:39], v3 offset:4096
    ds_read_b32 v7, v4 offset:4096
    ds_read_b32 v44, v5
    v_add_u32 v5, 1024, v5
    v_exp_f32 v164, v164
    v_exp_f32 v165, v165
    v_exp_f32 v166, v166
    v_exp_f32 v167, v167
    v_pk_fma_f32 v[152:153], v[152:153], v[48:49], 1.0 op_sel:[0,1,0] op_sel_hi:[1,1,0]
    v_pk_fma_f32 v[154:155], v[154:155], v[48:49], 1.0 op_sel:[0,1,0] op_sel_hi:[1,1,0]
    v_pk_fma_f32 v[156:157], v[156:157], v[48:49], 1.0 op_sel:[0,1,0] op_sel_hi:[1,1,0]
    v_pk_fma_f32 v[158:159], v[158:159], v[48:49], 1.0 op_sel:[0,1,0] op_sel_hi:[1,1,0]
    v_pk_fma_f32 v[160:161], v[160:161], v[48:49], 1.0 op_sel:[0,1,0] op_sel_hi:[1,1,0]
    v_pk_fma_f32 v[162:163], v[162:163], v[48:49], 1.0 op_sel:[0,1,0] op_sel_hi:[1,1,0]
    v_pk_fma_f32 v[164:165], v[164:165], v[48:49], 1.0 op_sel:[0,1,0] op_sel_hi:[1,1,0]
    v_pk_fma_f32 v[166:167], v[166:167], v[48:49], 1.0 op_sel:[0,1,0] op_sel_hi:[1,1,0]
    v_mfma_f32_32x32x16_bf16 v[168:183], v[200:203], v[104:107], 0
    v_rcp_f32 v152, v152
    v_rcp_f32 v153, v153
    v_rcp_f32 v154, v154
    v_mfma_f32_32x32x16_bf16 v[168:183], v[204:207], v[108:111], v[168:183]
    v_rcp_f32 v155, v155
    v_rcp_f32 v156, v156
    v_rcp_f32 v157, v157
    s_waitcnt lgkmcnt(0)
    v_add_u32 v7, v7, v1
    v_mad_u32_u16 v36, v36, s26, v28
    v_mad_u32_u16 v37, v37, s26, v29
    v_mad_u32_u16 v38, v38, s26, v30
    v_mad_u32_u16 v39, v39, s26, v31
    v_mfma_f32_32x32x16_bf16 v[168:183], v[208:211], v[112:115], v[168:183]
    v_rcp_f32 v158, v158
    v_rcp_f32 v159, v159
    v_rcp_f32 v160, v160
    v_mfma_f32_32x32x16_bf16 v[168:183], v[212:215], v[116:119], v[168:183]
    v_rcp_f32 v161, v161
    v_rcp_f32 v162, v162
    v_rcp_f32 v163, v163
    v_rcp_f32 v164, v164
    v_rcp_f32 v165, v165
    v_rcp_f32 v166, v166
    v_rcp_f32 v167, v167
    v_pk_mul_f32 v[56:57], v[152:153], v[184:185]
    v_pk_fma_f32 v[56:57], v[154:155], v[186:187], v[56:57]
    v_pk_fma_f32 v[56:57], v[156:157], v[188:189], v[56:57]
    v_pk_fma_f32 v[56:57], v[158:159], v[190:191], v[56:57]
    v_pk_fma_f32 v[56:57], v[160:161], v[192:193], v[56:57]
    v_pk_fma_f32 v[56:57], v[162:163], v[194:195], v[56:57]
    v_pk_fma_f32 v[56:57], v[164:165], v[196:197], v[56:57]
    v_pk_fma_f32 v[56:57], v[166:167], v[198:199], v[56:57]
    v_add_f32 v56, v56, v57
    v_cvt_f64_f32 v[56:57], v56
    ds_add_f64 v40, v[56:57] offset:1792
    v_add_u32_sdwa v40, v44, v6 dst_sel:DWORD dst_unused:UNUSED_PAD src0_sel:WORD_1 src1_sel:DWORD
    ds_read_b64 v[48:49], v40 offset:1024
    v_add_u32 v3, 2048, v3
    v_add_u32 v4, 2048, v4
    s_branch K_PURE0
K_LASTG:
    s_cmp_lg_u32 s30, 0
    s_cbranch_scc1 K_FB7
K_FR7:
    v_exp_f32 v152, v152
    v_exp_f32 v153, v153
    v_exp_f32 v154, v154
    v_exp_f32 v155, v155
    v_exp_f32 v156, v156
    v_exp_f32 v157, v157
    v_exp_f32 v158, v158
    v_exp_f32 v159, v159
    v_exp_f32 v160, v160
    v_exp_f32 v161, v161
    v_exp_f32 v162, v162
    v_exp_f32 v163, v163
    v_exp_f32 v164, v164
    v_exp_f32 v165, v165
    v_exp_f32 v166, v166
    v_exp_f32 v167, v167
    v_pk_fma_f32 v[152:153], v[152:153], v[48:49], 1.0 op_sel:[0,1,0] op_sel_hi:[1,1,0]
    v_pk_fma_f32 v[154:155], v[154:155], v[48:49], 1.0 op_sel:[0,1,0] op_sel_hi:[1,1,0]
    v_pk_fma_f32 v[156:157], v[156:157], v[50:51], 1.0 op_sel:[0,1,0] op_sel_hi:[1,1,0]
    v_pk_fma_f32 v[158:159], v[158:159], v[50:51], 1.0 op_sel:[0,1,0] op_sel_hi:[1,1,0]
    v_pk_fma_f32 v[160:161], v[160:161], v[52:53], 1.0 op_sel:[0,1,0] op_sel_hi:[1,1,0]
    v_pk_fma_f32 v[162:163], v[162:163], v[52:53], 1.0 op_sel:[0,1,0] op_sel_hi:[1,1,0]
    v_pk_fma_f32 v[164:165], v[164:165], v[54:55], 1.0 op_sel:[0,1,0] op_sel_hi:[1,1,0]
    v_pk_fma_f32 v[166:167], v[166:167], v[54:55], 1.0 op_sel:[0,1,0] op_sel_hi:[1,1,0]
    v_rcp_f32 v152, v152
    v_rcp_f32 v153, v153
    v_rcp_f32 v154, v154
    v_rcp_f32 v155, v155
    v_rcp_f32 v156, v156
    v_rcp_f32 v157, v157
    v_rcp_f32 v158, v158
    v_rcp_f32 v159, v159
    v_rcp_f32 v160, v160
    v_rcp_f32 v161, v161
    v_rcp_f32 v162, v162
    v_rcp_f32 v163, v163
    v_rcp_f32 v164, v164
    v_rcp_f32 v165, v165
    v_rcp_f32 v166, v166
    v_rcp_f32 v167, v167
    v_pk_mul_f32 v[56:57], v[152:153], v[184:185]
    v_pk_mul_f32 v[58:59], v[156:157], v[188:189]
    v_pk_mul_f32 v[60:61], v[160:161], v[192:193]
    v_pk_mul_f32 v[62:63], v[164:165], v[196:197]
    v_pk_fma_f32 v[56:57], v[154:155], v[186:187], v[56:57]
    v_pk_fma_f32 v[58:59], v[158:159], v[190:191], v[58:59]
    v_pk_fma_f32 v[60:61], v[162:163], v[194:195], v[60:61]
    v_pk_fma_f32 v[62:63], v[166:167], v[198:199], v[62:63]
    v_add_f32 v56, v56, v57
    v_add_f32 v58, v58, v59
    v_add_f32 v60, v60, v61
    v_add_f32 v62, v62, v63
    v_cvt_f64_f32 v[56:57], v56
    v_cvt_f64_f32 v[58:59], v58
    v_cvt_f64_f32 v[60:61], v60
    v_cvt_f64_f32 v[62:63], v62
    ds_add_f64 v40, v[56:57] offset:1792
    ds_add_f64 v41, v[58:59] offset:1792
    ds_add_f64 v42, v[60:61] offset:1792
    ds_add_f64 v43, v[62:63] offset:1792
    s_branch K_WEND
K_FB1:
    s_waitcnt lgkmcnt(0)
    ds_read_b32 v48, v40 offset:1280
    ds_read_b32 v50, v41 offset:1280
    ds_read_b32 v52, v42 offset:1280
    ds_read_b32 v54, v43 offset:1280
    s_waitcnt lgkmcnt(0)
    s_nop 7
    v_add_f32 v136, v136, v48
    v_add_f32 v137, v137, v48
    v_add_f32 v138, v138, v48
    v_add_f32 v139, v139, v48
    v_add_f32 v140, v140, v50
    v_add_f32 v141, v141, v50
    v_add_f32 v142, v142, v50
    v_add_f32 v143, v143, v50
    v_add_f32 v144, v144, v52
    v_add_f32 v145, v145, v52
    v_add_f32 v146, v146, v52
    v_add_f32 v147, v147, v52
    v_add_f32 v148, v148, v54
    v_add_f32 v149, v149, v54
    v_add_f32 v150, v150, v54
    v_add_f32 v151, v151, v54
    v_mov_b32 v48, 1.0
    v_mov_b32 v50, 1.0
    v_mov_b32 v52, 1.0
    v_mov_b32 v54, 1.0
    s_branch K_FR1
K_FB2:
    s_waitcnt lgkmcnt(0)
    ds_read_b32 v49, v40 offset:1284
    ds_read_b32 v51, v41 offset:1284
    ds_read_b32 v53, v42 offset:1284
    ds_read_b32 v55, v43 offset:1284
    s_waitcnt lgkmcnt(0)
    s_nop 7
    v_add_f32 v152, v152, v49
    v_add_f32 v153, v153, v49
    v_add_f32 v154, v154, v49
    v_add_f32 v155, v155, v49
    v_add_f32 v156, v156, v51
    v_add_f32 v157, v157, v51
    v_add_f32 v158, v158, v51
    v_add_f32 v159, v159, v51
    v_add_f32 v160, v160, v53
    v_add_f32 v161, v161, v53
    v_add_f32 v162, v162, v53
    v_add_f32 v163, v163, v53
    v_add_f32 v164, v164, v55
    v_add_f32 v165, v165, v55
    v_add_f32 v166, v166, v55
    v_add_f32 v167, v167, v55
    v_mov_b32 v49, 1.0
    v_mov_b32 v51, 1.0
    v_mov_b32 v53, 1.0
    v_mov_b32 v55, 1.0
    s_branch K_FR2
K_FB3:
    s_waitcnt lgkmcnt(0)
    ds_read_b32 v48, v40 offset:1280
    ds_read_b32 v50, v41 offset:1280
    ds_read_b32 v52, v42 offset:1280
    ds_read_b32 v54, v43 offset:1280
    s_waitcnt lgkmcnt(0)
    s_nop 7
    v_add_f32 v136, v136, v48
    v_add_f32 v137, v137, v48
    v_add_f32 v138, v138, v48
    v_add_f32 v139, v139, v48
    v_add_f32 v140, v140, v50
    v_add_f32 v141, v141, v50
    v_add_f32 v142, v142, v50
    v_add_f32 v143, v143, v50
    v_add_f32 v144, v144, v52
    v_add_f32 v145, v145, v52
    v_add_f32 v146, v146, v52
    v_add_f32 v147, v147, v52
    v_add_f32 v148, v148, v54
    v_add_f32 v149, v149, v54
    v_add_f32 v150, v150, v54
    v_add_f32 v151, v151, v54
    v_mov_b32 v48, 1.0
    v_mov_b32 v50, 1.0
    v_mov_b32 v52, 1.0
    v_mov_b32 v54, 1.0
    s_branch K_FR3
K_FB4:
    s_waitcnt lgkmcnt(0)
    ds_read_b32 v49, v40 offset:1284
    ds_read_b32 v51, v41 offset:1284
    ds_read_b32 v53, v42 offset:1284
    ds_read_b32 v55, v43 offset:1284
    s_waitcnt lgkmcnt(0)
    s_nop 7
    v_add_f32 v152, v152, v49
    v_add_f32 v153, v153, v49
    v_add_f32 v154, v154, v49
    v_add_f32 v155, v155, v49
    v_add_f32 v156, v156, v51
    v_add_f32 v157, v157, v51
    v_add_f32 v158, v158, v51
    v_add_f32 v159, v159, v51
    v_add_f32 v160, v160, v53
    v_add_f32 v161, v161, v53
    v_add_f32 v162, v162, v53
    v_add_f32 v163, v163, v53
    v_add_f32 v164, v164, v55
    v_add_f32 v165, v165, v55
    v_add_f32 v166, v166, v55
    v_add_f32 v167, v167, v55
    v_mov_b32 v49, 1.0
    v_mov_b32 v51, 1.0
    v_mov_b32 v53, 1.0
    v_mov_b32 v55, 1.0
    s_branch K_FR4
K_PB5:
    s_setprio 2
    s_cmp_lg_u32 s20, 1
    s_cbranch_scc1 K_PR5
    s_setprio 1
    s_branch K_PR5
K_PB6:
    s_setprio 2
    s_cmp_lg_u32 s20, 1
    s_cbranch_scc1 K_PR6
    s_setprio 1
    s_branch K_PR6
K_FB7:
    s_waitcnt lgkmcnt(0)
    ds_read_b32 v49, v40 offset:1284
    ds_read_b32 v51, v41 offset:1284
    ds_read_b32 v53, v42 offset:1284
    ds_read_b32 v55, v43 offset:1284
    s_waitcnt lgkmcnt(0)
    s_nop 7
    v_add_f32 v152, v152, v49
    v_add_f32 v153, v153, v49
    v_add_f32 v154, v154, v49
    v_add_f32 v155, v155, v49
    v_add_f32 v156, v156, v51
    v_add_f32 v157, v157, v51
    v_add_f32 v158, v158, v51
    v_add_f32 v159, v159, v51
    v_add_f32 v160, v160, v53
    v_add_f32 v161, v161, v53
    v_add_f32 v162, v162, v53
    v_add_f32 v163, v163, v53
    v_add_f32 v164, v164, v55
    v_add_f32 v165, v165, v55
    v_add_f32 v166, v166, v55
    v_add_f32 v167, v167, v55
    v_mov_b32 v49, 1.0
    v_mov_b32 v51, 1.0
    v_mov_b32 v53, 1.0
    v_mov_b32 v55, 1.0
    s_branch K_FR7
K_LASTP:
    s_setprio 0
    v_exp_f32 v152, v152
    v_exp_f32 v153, v153
    v_exp_f32 v154, v154
    v_exp_f32 v155, v155
    v_exp_f32 v156, v156
    v_exp_f32 v157, v157
    v_exp_f32 v158, v158
    v_exp_f32 v159, v159
    v_exp_f32 v160, v160
    v_exp_f32 v161, v161
    v_exp_f32 v162, v162
    v_exp_f32 v163, v163
    v_exp_f32 v164, v164
    v_exp_f32 v165, v165
    v_exp_f32 v166, v166
    v_exp_f32 v167, v167
    v_pk_fma_f32 v[152:153], v[152:153], v[48:49], 1.0 op_sel:[0,1,0] op_sel_hi:[1,1,0]
    v_pk_fma_f32 v[154:155], v[154:155], v[48:49], 1.0 op_sel:[0,1,0] op_sel_hi:[1,1,0]
    v_pk_fma_f32 v[156:157], v[156:157], v[48:49], 1.0 op_sel:[0,1,0] op_sel_hi:[1,1,0]
    v_pk_fma_f32 v[158:159], v[158:159], v[48:49], 1.0 op_sel:[0,1,0] op_sel_hi:[1,1,0]
    v_pk_fma_f32 v[160:161], v[160:161], v[48:49], 1.0 op_sel:[0,1,0] op_sel_hi:[1,1,0]
    v_pk_fma_f32 v[162:163], v[162:163], v[48:49], 1.0 op_sel:[0,1,0] op_sel_hi:[1,1,0]
    v_pk_fma_f32 v[164:165], v[164:165], v[48:49], 1.0 op_sel:[0,1,0] op_sel_hi:[1,1,0]
    v_pk_fma_f32 v[166:167], v[166:167], v[48:49], 1.0 op_sel:[0,1,0] op_sel_hi:[1,1,0]
    v_rcp_f32 v152, v152
    v_rcp_f32 v153, v153
    v_rcp_f32 v154, v154
    v_rcp_f32 v155, v155
    v_rcp_f32 v156, v156
    v_rcp_f32 v157, v157
    v_rcp_f32 v158, v158
    v_rcp_f32 v159, v159
    v_rcp_f32 v160, v160
    v_rcp_f32 v161, v161
    v_rcp_f32 v162, v162
    v_rcp_f32 v163, v163
    v_rcp_f32 v164, v164
    v_rcp_f32 v165, v165
    v_rcp_f32 v166, v166
    v_rcp_f32 v167, v167
    v_pk_mul_f32 v[56:57], v[152:153], v[184:185]
    v_pk_fma_f32 v[56:57], v[154:155], v[186:187], v[56:57]
    v_pk_fma_f32 v[56:57], v[156:157], v[188:189], v[56:57]
    v_pk_fma_f32 v[56:57], v[158:159], v[190:191], v[56:57]
    v_pk_fma_f32 v[56:57], v[160:161], v[192:193], v[56:57]
    v_pk_fma_f32 v[56:57], v[162:163], v[194:195], v[56:57]
    v_pk_fma_f32 v[56:57], v[164:165], v[196:197], v[56:57]
    v_pk_fma_f32 v[56:57], v[166:167], v[198:199], v[56:57]
    v_add_f32 v56, v56, v57
    v_cvt_f64_f32 v[56:57], v56
    ds_add_f64 v40, v[56:57] offset:1792
K_WEND:
    s_waitcnt vmcnt(0) lgkmcnt(0)
    s_sub_u32 s24, s24, 1
    s_cmp_gt_i32 s24, 0
    s_cbranch_scc1 K_ROUND
    v_lshrrev_b32 v9, 3, v0
    v_and_b32 v11, 7, v0
    v_lshlrev_b32 v9, 10, v9
    v_lshl_add_u32 v9, v11, 6, v9
    v_add_u32 v8, s25, v23
    v_cmp_gt_u32 vcc, s32, v0
    s_mov_b32 s21, 0xbfb8aa3b
    s_barrier
    s_or_b32 s22, s18, s2
    s_cmp_lg_u32 s22, 0
    s_cbranch_scc1 K_NOTAG
    v_mov_b32 v10, s88
    s_mov_b32 s22, 4554752
    s_mov_b64 exec, 1
    buffer_store_dword v10, v18, s[12:15], s22 offen sc1
    s_mov_b64 exec, -1
K_NOTAG:
    s_and_b64 exec, exec, vcc
    s_cbranch_scc0 K_FIN
    ds_read_b128 v[152:155], v9 offset:1536
    ds_read_b128 v[156:159], v9 offset:1552
    ds_read_b128 v[160:163], v9 offset:1568
    ds_read_b128 v[164:167], v9 offset:1584
    s_waitcnt lgkmcnt(0)
    v_cvt_f32_f64 v136, v[152:153]
    v_cvt_f32_f64 v137, v[154:155]
    v_cvt_f32_f64 v138, v[156:157]
    v_cvt_f32_f64 v139, v[158:159]
    v_cvt_f32_f64 v140, v[160:161]
    v_cvt_f32_f64 v141, v[162:163]
    v_cvt_f32_f64 v142, v[164:165]
    v_cvt_f32_f64 v143, v[166:167]
    v_mul_f32 v168, s21, v136
    v_mul_f32 v169, s21, v137
    v_mul_f32 v170, s21, v138
    v_mul_f32 v171, s21, v139
    v_mul_f32 v172, s21, v140
    v_mul_f32 v173, s21, v141
    v_mul_f32 v174, s21, v142
    v_mul_f32 v175, s21, v143
    v_exp_f32 v168, v168
    v_exp_f32 v169, v169
    v_exp_f32 v170, v170
    v_exp_f32 v171, v171
    v_exp_f32 v172, v172
    v_exp_f32 v173, v173
    v_exp_f32 v174, v174
    v_exp_f32 v175, v175
    v_add_f32 v168, 1.0, v168
    v_add_f32 v169, 1.0, v169
    v_add_f32 v170, 1.0, v170
    v_add_f32 v171, 1.0, v171
    v_add_f32 v172, 1.0, v172
    v_add_f32 v173, 1.0, v173
    v_add_f32 v174, 1.0, v174
    v_add_f32 v175, 1.0, v175
    v_rcp_f32 v168, v168
    v_rcp_f32 v169, v169
    v_rcp_f32 v170, v170
    v_rcp_f32 v171, v171
    v_rcp_f32 v172, v172
    v_rcp_f32 v173, v173
    v_rcp_f32 v174, v174
    v_rcp_f32 v175, v175
    v_mul_f32 v136, v136, v168
    v_mul_f32 v137, v137, v169
    v_mul_f32 v138, v138, v170
    v_mul_f32 v139, v139, v171
    v_mul_f32 v140, v140, v172
    v_mul_f32 v141, v141, v173
    v_mul_f32 v142, v142, v174
    v_mul_f32 v143, v143, v175
    v_cvt_pk_bf16_f32 v176, v136, v137
    v_cvt_pk_bf16_f32 v177, v138, v139
    v_cvt_pk_bf16_f32 v178, v140, v141
    v_cvt_pk_bf16_f32 v179, v142, v143
    global_store_dwordx4 v8, v[176:179], s[16:17] sc1
K_FIN:
K_END:
s_endpgm
.section .rodata,"a"
.p2align 6
.amdhsa_kernel standalone__edge_featured_mpnn_egc__graph_kernel
  .amdhsa_next_free_vgpr 248
  .amdhsa_next_free_sgpr 102
  .amdhsa_accum_offset 248
  .amdhsa_group_segment_fixed_size 0
  .amdhsa_kernarg_size 80
  .amdhsa_user_sgpr_count 2
  .amdhsa_user_sgpr_kernarg_segment_ptr 1
  .amdhsa_system_sgpr_workgroup_id_x 1
.end_amdhsa_kernel
```
